```python
import torch

def _softmax(x, axis=-1):
    return torch.softmax(x, dim=axis)

def _gelu(x):
    return torch.nn.functional.gelu(x, approximate='tanh')

def _silu(x):
    return torch.nn.functional.silu(x)

def _sigmoid(x):
    return torch.sigmoid(x)

def _layernorm(x, axis=-1, eps=1e-05):
    m = x.mean(dim=axis, keepdim=True)
    v = x.var(dim=axis, keepdim=True, unbiased=False)
    return (x - m) / torch.sqrt(v + eps)

def _scatter_add(tgt, idx, src, axis=0):
    return tgt.clone().index_add_(axis, idx, src)

def _segment_sum(src, seg, n):
    out = torch.zeros((n,) + src.shape[1:], dtype=src.dtype)
    return out.index_add_(0, seg, src)

def _pad(x, pw):
    flat = tuple((v for pair in reversed(pw) for v in pair))
    return torch.nn.functional.pad(x, flat)
kernel_name = 'adaLN_cond__sliding_block_cached__swiglu_ffn__decode'

def setup_inputs():

    _w = lambda a: (lambda t: t.to(torch.bfloat16) if t.is_floating_point() else t)(torch.as_tensor(a))

    def _A_setup():
        B, Sq, D = (8, 1, 1024)
        Hq, Hkv, Sk, Dh = (32, 4, 4096, 128)
        assert Hq % Hkv == 0, (Hq, Hkv)
        return {'x': _w((lambda *s: torch.randn(*s, dtype=torch.bfloat16) * 0.05)(B, Sq, D)), 'k_cache': _w((lambda *s: torch.randn(*s, dtype=torch.bfloat16) * 3.2)(B, Hkv, Sk, Dh)), 'v_cache': _w((lambda *s: torch.randn(*s, dtype=torch.bfloat16) * 0.4)(B, Hkv, Sk, Dh)), 'wq': _w((lambda *s: torch.randn(*s, dtype=torch.bfloat16) * 3.2)(D, Hq * Dh) * D ** (-0.5)), 'wo': _w((lambda *s: torch.randn(*s, dtype=torch.bfloat16) * 0.4)(Hq * Dh, D) * (Hq * Dh) ** (-0.5))}
    _A_in = _A_setup()

    def _B_setup():
        B, S, D, F = (8, 1, 1024, 3584)
        return {'x': _w((lambda *s: torch.randn(*s, dtype=torch.bfloat16) * 0.05)(B, S, D)), 'w_gate': _w((lambda *s: torch.randn(*s, dtype=torch.bfloat16) * 0.05)(D, F)), 'w_up': _w((lambda *s: torch.randn(*s, dtype=torch.bfloat16) * 0.05)(D, F)), 'w_down': _w((lambda *s: torch.randn(*s, dtype=torch.bfloat16) * 0.05)(F, D))}
    _B_in = _B_setup()
    return {'A_x': _A_in['x'], 'A_k_cache': _A_in['k_cache'], 'A_v_cache': _A_in['v_cache'], 'A_wq': _A_in['wq'], 'A_wo': _A_in['wo'], 'B_x': _B_in['x'], 'B_w_gate': _B_in['w_gate'], 'B_w_up': _B_in['w_up'], 'B_w_down': _B_in['w_down'], 'c': _w((lambda *s: torch.randn(*s, dtype=torch.bfloat16) * 0.1)(8, 1024) * 8.0), 'w_mod': _w((lambda *s: torch.randn(*s, dtype=torch.bfloat16) * 0.1)(1024, 6 * 1024) * 1024 ** (-0.5) * 8.0)}

def reference(A_x, A_k_cache, A_v_cache, A_wq, A_wo, B_x, B_w_gate, B_w_up, B_w_down, c, w_mod):

    def _A_ref(x, k_cache, v_cache, wq, wo):
        B, Sq, D = x.shape
        Hq, Dh = (32, 128)
        Hkv, Sk = (k_cache.shape[1], k_cache.shape[2])
        W = min(4096, max(256, Sk // 4))
        rep = Hq // Hkv
        q = (lambda x, *d: x.permute(*d))((x @ wq).reshape(B, Sq, Hq, Dh), 0, 2, 1, 3)
        k = (lambda x, n, axis: torch.repeat_interleave(x, n, dim=axis))(k_cache[:, :, Sk - W:, :], rep, axis=1)
        v = (lambda x, n, axis: torch.repeat_interleave(x, n, dim=axis))(v_cache[:, :, Sk - W:, :], rep, axis=1)
        scores = torch.einsum('bhqd,bhkd->bhqk', q, k) * Dh ** (-0.5)
        p = _softmax(scores, axis=-1)
        o = torch.einsum('bhqk,bhkd->bhqd', p, v)
        return (lambda x, *d: x.permute(*d))(o, 0, 2, 1, 3).reshape(B, Sq, Hq * Dh) @ wo

    def _B_ref(x, w_gate, w_up, w_down):
        g = _silu(x @ w_gate)
        u = x @ w_up
        return g * u @ w_down
    x = A_x
    mod = (_silu(c) @ w_mod).reshape(c.shape[0], 6, 1, -1)
    sa, ca, ga, sb, cb, gb = (mod[:, 0].clone(), mod[:, 1].clone(), mod[:, 2].clone(), mod[:, 3].clone(), mod[:, 4].clone(), mod[:, 5].clone())
    h = _layernorm(x, axis=-1) * (1 + ca) + sa
    x = x + ga * _A_ref(h, A_k_cache, A_v_cache, A_wq, A_wo)
    h = _layernorm(x, axis=-1) * (1 + cb) + sb
    x = x + gb * _B_ref(h, B_w_gate, B_w_up, B_w_down)
    return x
```

```asm
; @launch grid=(256,1,1) block=(1024,1,1) lds=110592
.amdgcn_target "amdgcn-amd-amdhsa--gfx950"
.text
.globl adaLN_cond__sliding_block_cached__swiglu_ffn__decode_kernel
.p2align 8
.type adaLN_cond__sliding_block_cached__swiglu_ffn__decode_kernel,@function
adaLN_cond__sliding_block_cached__swiglu_ffn__decode_kernel:
L_start:
    s_load_dwordx16 s[4:19], s[0:1], 0
    s_load_dwordx8 s[20:27], s[0:1], 64
    s_load_dwordx4 s[28:31], s[0:1], 96
    s_getpc_b64 s[44:45]
L_pct:
    s_lshr_b32 s49, s2, 3
    v_lshrrev_b32 v4, 6, v0
    s_lshl_b32 s56, s49, 11
    s_and_b32 s56, s56, 0x7fff
    v_lshl_add_u32 v5, v4, 7, s56
    v_min_u32 v5, L_end-L_pct, v5
    global_load_dword v127, v5, s[44:45]
    s_cmp_ge_u32 s2, 256
    s_cbranch_scc1 L_end
    v_lshrrev_b32 v4, 6, v0
    v_and_b32 v0, 63, v0
    v_readfirstlane_b32 s50, v4
    v_and_b32 v1, 15, v0
    v_lshrrev_b32 v2, 4, v0
    s_and_b32 s48, s2, 7
    s_lshr_b32 s49, s2, 3
    s_and_b32 s98, s49, 15
    s_mov_b32 s53, 0x05040100
    s_mov_b32 s54, 0x07060302
    s_mov_b32 s55, 0xffff0000
    v_lshlrev_b32 v4, 2, v0
    v_mov_b32 v5, 0
    ds_write_b32 v4, v5 offset:0
    s_cmp_ge_u32 s50, 8
    s_cbranch_scc1 L_gen
    s_cmp_ge_u32 s49, 16
    s_cbranch_scc1 L_FQ
    s_cmp_ge_u32 s50, 4
    s_cbranch_scc1 L_ES
L_EM:
    s_lshr_b32 s56, s50, 1
    s_and_b32 s57, s50, 1
    s_mul_i32 s67, s98, 786432
    s_lshl_b32 s60, s48, 8
    s_add_u32 s67, s67, s60
    s_lshl_b32 s60, s57, 7
    s_add_u32 s67, s67, s60
    s_lshl_b32 s60, s56, 11
    s_add_u32 s67, s67, s60
    v_lshrrev_b32 v5, 3, v1
    v_lshl_add_u32 v5, v5, 2, v2
    s_mov_b32 s62, 98304
    v_mul_lo_u32 v5, v5, s62
    v_and_b32 v7, 7, v1
    v_lshl_add_u32 v7, v7, 4, v5
    v_lshrrev_b32 v5, 3, v1
    v_lshl_add_u32 v5, v5, 2, v2
    v_lshlrev_b32 v5, 4, v5
    v_and_b32 v6, 7, v1
    s_mov_b32 s62, 2048
    v_mul_lo_u32 v6, v6, s62
    v_add_u32 v6, v6, v5
    s_lshl_b32 s59, s98, 7
    s_waitcnt lgkmcnt(0)
    s_mov_b32 s40, s22
    s_mov_b32 s41, s23
    s_mov_b32 s42, 16384
    s_mov_b32 s43, 0x20000
    buffer_load_dwordx4 v[8:11], v6, s[40:43], s59 offen
    s_mov_b32 s36, s24
    s_mov_b32 s37, s25
    s_mov_b32 s38, 12582912
    s_mov_b32 s39, 0x20000
    buffer_load_dwordx4 v[64:67], v7, s[36:39], s67 offen offset:0 nt
    s_add_u32 s62, s67, 12288
    buffer_load_dwordx4 v[68:71], v7, s[36:39], s62 offen nt
    s_add_u32 s62, s67, 24576
    buffer_load_dwordx4 v[72:75], v7, s[36:39], s62 offen nt
    s_add_u32 s62, s67, 36864
    buffer_load_dwordx4 v[76:79], v7, s[36:39], s62 offen nt
    s_add_u32 s62, s67, 49152
    buffer_load_dwordx4 v[80:83], v7, s[36:39], s62 offen nt
    s_add_u32 s62, s67, 61440
    buffer_load_dwordx4 v[84:87], v7, s[36:39], s62 offen nt
    s_add_u32 s62, s67, 73728
    buffer_load_dwordx4 v[88:91], v7, s[36:39], s62 offen nt
    s_add_u32 s62, s67, 86016
    buffer_load_dwordx4 v[92:95], v7, s[36:39], s62 offen nt
    s_load_dword s64, s[30:31], 0
    s_barrier
    s_branch L_EM2
L_gen:
    s_cmp_lt_u32 s49, 16
    s_cbranch_scc1 L_gen2
    s_cmp_ge_u32 s50, 12
    s_cbranch_scc1 L_gen2
    s_waitcnt lgkmcnt(0)
    s_mov_b32 s36, s4
    s_mov_b32 s37, s5
    s_mov_b32 s38, 16384
    s_mov_b32 s39, 0x20000
    s_sub_u32 s56, s50, 8
    s_lshl_b32 s57, s56, 12
    v_lshlrev_b32 v4, 6, v0
    buffer_load_dwordx4 v[32:35], v4, s[36:39], s57 offen offset:0
    buffer_load_dwordx4 v[36:39], v4, s[36:39], s57 offen offset:16
    buffer_load_dwordx4 v[40:43], v4, s[36:39], s57 offen offset:32
    buffer_load_dwordx4 v[44:47], v4, s[36:39], s57 offen offset:48
L_gen2:
    s_waitcnt lgkmcnt(0)
    s_load_dword s64, s[30:31], 0
    s_barrier
    s_cmp_lt_u32 s49, 16
    s_cbranch_scc1 L_EA
    s_cmp_ge_u32 s50, 14
    s_cbranch_scc1 L_FR
    s_branch L_FM
L_ES:
    s_sub_u32 s56, s50, 4
    s_waitcnt lgkmcnt(0)
    s_load_dword s64, s[30:31], 0
    s_barrier
    s_branch L_ES2
L_FQ:
    v_lshrrev_b32 v5, 3, v1
    v_lshl_add_u32 v5, v5, 2, v2
    s_mov_b32 s62, 8192
    v_mul_lo_u32 v5, v5, s62
    v_and_b32 v7, 7, v1
    v_lshl_add_u32 v7, v7, 4, v5
    s_lshr_b32 s68, s48, 1
    s_lshl_b32 s68, s68, 4
    s_add_u32 s68, s68, s98
    s_and_b32 s67, s48, 1
    s_lshl_b32 s58, s67, 3
    s_add_u32 s58, s58, s50
    s_lshl_b32 s59, s58, 19
    s_lshl_b32 s57, s68, 7
    s_add_u32 s59, s59, s57
    s_waitcnt lgkmcnt(0)
    s_mov_b32 s36, s10
    s_mov_b32 s37, s11
    s_mov_b32 s38, 8388608
    s_mov_b32 s39, 0x20000
    s_load_dword s64, s[30:31], 0
    s_barrier
    s_branch L_FQ2
L_EM2:
    s_mov_b32 s32, s30
    s_mov_b32 s33, s31
    s_mov_b32 s34, 268435456
    s_mov_b32 s35, 0x20000
    s_mov_b32 s58, 0
    s_lshl_b32 s68, s58, 20
    s_lshl_b32 s60, s48, 17
    s_add_u32 s68, s68, s60
    s_add_u32 s68, s68, 3145728
    s_lshl_b32 s60, s57, 16
    s_add_u32 s68, s68, s60
    s_lshl_b32 s60, s56, 11
    s_add_u32 s68, s68, s60
    s_lshl_b32 s60, s98, 7
    s_add_u32 s68, s68, s60
    v_lshlrev_b32 v26, 4, v0
    v_lshrrev_b32 v4, 3, v1
    v_lshrrev_b32 v5, 1, v2
    v_lshl_add_u32 v4, v5, 1, v4
    v_and_b32 v5, 1, v2
    v_lshl_add_u32 v4, v4, 2, v5
    v_lshlrev_b32 v24, 12, v4
    v_and_b32 v4, 7, v1
    v_lshl_add_u32 v24, v4, 4, v24
    v_add_u32 v25, 0x2000, v24
    s_mov_b32 s52, 0x1ff
    s_waitcnt lgkmcnt(0)
    s_add_u32 s51, s64, 1
    s_and_b32 s51, s51, 0xff
    s_or_b32 s51, s51, 0xf00
    v_mov_b32 v3, s51
    s_waitcnt vmcnt(8)
    v_lshlrev_b32 v12, 16, v8
    v_and_b32 v13, 0xffff0000, v8
    v_lshlrev_b32 v14, 16, v9
    v_and_b32 v15, 0xffff0000, v9
    v_lshlrev_b32 v16, 16, v10
    v_and_b32 v17, 0xffff0000, v10
    v_lshlrev_b32 v18, 16, v11
    v_and_b32 v19, 0xffff0000, v11
    v_mul_f32 v4, 0xbfb8aa3b, v12
    v_exp_f32 v4, v4
    s_nop 0
    v_add_f32 v4, 1.0, v4
    v_rcp_f32 v4, v4
    s_nop 0
    v_mul_f32 v12, v12, v4
    v_mul_f32 v5, 0xbfb8aa3b, v13
    v_exp_f32 v5, v5
    s_nop 0
    v_add_f32 v5, 1.0, v5
    v_rcp_f32 v5, v5
    s_nop 0
    v_mul_f32 v13, v13, v5
    v_mul_f32 v4, 0xbfb8aa3b, v14
    v_exp_f32 v4, v4
    s_nop 0
    v_add_f32 v4, 1.0, v4
    v_rcp_f32 v4, v4
    s_nop 0
    v_mul_f32 v14, v14, v4
    v_mul_f32 v5, 0xbfb8aa3b, v15
    v_exp_f32 v5, v5
    s_nop 0
    v_add_f32 v5, 1.0, v5
    v_rcp_f32 v5, v5
    s_nop 0
    v_mul_f32 v15, v15, v5
    v_mul_f32 v4, 0xbfb8aa3b, v16
    v_exp_f32 v4, v4
    s_nop 0
    v_add_f32 v4, 1.0, v4
    v_rcp_f32 v4, v4
    s_nop 0
    v_mul_f32 v16, v16, v4
    v_mul_f32 v5, 0xbfb8aa3b, v17
    v_exp_f32 v5, v5
    s_nop 0
    v_add_f32 v5, 1.0, v5
    v_rcp_f32 v5, v5
    s_nop 0
    v_mul_f32 v17, v17, v5
    v_mul_f32 v4, 0xbfb8aa3b, v18
    v_exp_f32 v4, v4
    s_nop 0
    v_add_f32 v4, 1.0, v4
    v_rcp_f32 v4, v4
    s_nop 0
    v_mul_f32 v18, v18, v4
    v_mul_f32 v5, 0xbfb8aa3b, v19
    v_exp_f32 v5, v5
    s_nop 0
    v_add_f32 v5, 1.0, v5
    v_rcp_f32 v5, v5
    s_nop 0
    v_mul_f32 v19, v19, v5
    v_cvt_pk_bf16_f32 v28, v12, v13
    v_cvt_pk_bf16_f32 v29, v14, v15
    v_cvt_pk_bf16_f32 v30, v16, v17
    v_cvt_pk_bf16_f32 v31, v18, v19
    s_waitcnt vmcnt(6)
    v_perm_b32 v32, v68, v64, s53
    v_perm_b32 v36, v68, v64, s54
    v_perm_b32 v40, v69, v65, s53
    v_perm_b32 v44, v69, v65, s54
    v_perm_b32 v48, v70, v66, s53
    v_perm_b32 v52, v70, v66, s54
    v_perm_b32 v56, v71, v67, s53
    v_perm_b32 v60, v71, v67, s54
    s_waitcnt vmcnt(4)
    v_perm_b32 v33, v76, v72, s53
    v_perm_b32 v37, v76, v72, s54
    v_perm_b32 v41, v77, v73, s53
    v_perm_b32 v45, v77, v73, s54
    v_perm_b32 v49, v78, v74, s53
    v_perm_b32 v53, v78, v74, s54
    v_perm_b32 v57, v79, v75, s53
    v_perm_b32 v61, v79, v75, s54
    s_waitcnt vmcnt(2)
    v_perm_b32 v34, v84, v80, s53
    v_perm_b32 v38, v84, v80, s54
    v_perm_b32 v42, v85, v81, s53
    v_perm_b32 v46, v85, v81, s54
    v_perm_b32 v50, v86, v82, s53
    v_perm_b32 v54, v86, v82, s54
    v_perm_b32 v58, v87, v83, s53
    v_perm_b32 v62, v87, v83, s54
    s_waitcnt vmcnt(0)
    v_perm_b32 v35, v92, v88, s53
    v_perm_b32 v39, v92, v88, s54
    v_perm_b32 v43, v93, v89, s53
    v_perm_b32 v47, v93, v89, s54
    v_perm_b32 v51, v94, v90, s53
    v_perm_b32 v55, v94, v90, s54
    v_perm_b32 v59, v95, v91, s53
    v_perm_b32 v63, v95, v91, s54
    v_mfma_f32_16x16x32_bf16 v[96:99], v[28:31], v[32:35], 0
    v_mfma_f32_16x16x32_bf16 v[100:103], v[28:31], v[36:39], 0
    v_mfma_f32_16x16x32_bf16 v[104:107], v[28:31], v[40:43], 0
    v_mfma_f32_16x16x32_bf16 v[108:111], v[28:31], v[44:47], 0
    v_mfma_f32_16x16x32_bf16 v[112:115], v[28:31], v[48:51], 0
    v_mfma_f32_16x16x32_bf16 v[116:119], v[28:31], v[52:55], 0
    v_mfma_f32_16x16x32_bf16 v[120:123], v[28:31], v[56:59], 0
    v_mfma_f32_16x16x32_bf16 v[124:127], v[28:31], v[60:63], 0
    s_nop 4
    v_permlane32_swap_b32 v96, v112
    v_permlane32_swap_b32 v97, v113
    v_permlane32_swap_b32 v98, v114
    v_permlane32_swap_b32 v99, v115
    v_permlane32_swap_b32 v100, v116
    v_permlane32_swap_b32 v101, v117
    v_permlane32_swap_b32 v102, v118
    v_permlane32_swap_b32 v103, v119
    v_permlane32_swap_b32 v104, v120
    v_permlane32_swap_b32 v105, v121
    v_permlane32_swap_b32 v106, v122
    v_permlane32_swap_b32 v107, v123
    v_permlane32_swap_b32 v108, v124
    v_permlane32_swap_b32 v109, v125
    v_permlane32_swap_b32 v110, v126
    v_permlane32_swap_b32 v111, v127
    v_add_f32_dpp v96, v112, v96 row_ror:8 row_mask:0xf bank_mask:0xf
    v_add_f32_dpp v97, v113, v97 row_ror:8 row_mask:0xf bank_mask:0xf
    v_add_f32_dpp v98, v114, v98 row_ror:8 row_mask:0xf bank_mask:0xf
    v_add_f32_dpp v99, v115, v99 row_ror:8 row_mask:0xf bank_mask:0xf
    v_add_f32_dpp v100, v116, v100 row_ror:8 row_mask:0xf bank_mask:0xf
    v_add_f32_dpp v101, v117, v101 row_ror:8 row_mask:0xf bank_mask:0xf
    v_add_f32_dpp v102, v118, v102 row_ror:8 row_mask:0xf bank_mask:0xf
    v_add_f32_dpp v103, v119, v103 row_ror:8 row_mask:0xf bank_mask:0xf
    v_add_f32_dpp v104, v120, v104 row_ror:8 row_mask:0xf bank_mask:0xf
    v_add_f32_dpp v105, v121, v105 row_ror:8 row_mask:0xf bank_mask:0xf
    v_add_f32_dpp v106, v122, v106 row_ror:8 row_mask:0xf bank_mask:0xf
    v_add_f32_dpp v107, v123, v107 row_ror:8 row_mask:0xf bank_mask:0xf
    v_add_f32_dpp v108, v124, v108 row_ror:8 row_mask:0xf bank_mask:0xf
    v_add_f32_dpp v109, v125, v109 row_ror:8 row_mask:0xf bank_mask:0xf
    v_add_f32_dpp v110, v126, v110 row_ror:8 row_mask:0xf bank_mask:0xf
    v_add_f32_dpp v111, v127, v111 row_ror:8 row_mask:0xf bank_mask:0xf
    v_mov_b32_dpp v96, v104 row_ror:8 row_mask:0xf bank_mask:0xc
    v_mov_b32_dpp v97, v105 row_ror:8 row_mask:0xf bank_mask:0xc
    v_mov_b32_dpp v98, v106 row_ror:8 row_mask:0xf bank_mask:0xc
    v_mov_b32_dpp v99, v107 row_ror:8 row_mask:0xf bank_mask:0xc
    v_mov_b32_dpp v100, v108 row_ror:8 row_mask:0xf bank_mask:0xc
    v_mov_b32_dpp v101, v109 row_ror:8 row_mask:0xf bank_mask:0xc
    v_mov_b32_dpp v102, v110 row_ror:8 row_mask:0xf bank_mask:0xc
    v_mov_b32_dpp v103, v111 row_ror:8 row_mask:0xf bank_mask:0xc
    v_bfi_b32 v96, s52, v3, v96
    v_bfi_b32 v97, s52, v3, v97
    v_bfi_b32 v98, s52, v3, v98
    v_bfi_b32 v99, s52, v3, v99
    v_bfi_b32 v100, s52, v3, v100
    v_bfi_b32 v101, s52, v3, v101
    v_bfi_b32 v102, s52, v3, v102
    v_bfi_b32 v103, s52, v3, v103
    buffer_store_dwordx4 v[96:99], v24, s[32:35], s68 offen
    buffer_store_dwordx4 v[100:103], v25, s[32:35], s68 offen
    v_mov_b32 v4, 4
    v_mov_b32 v5, 1
    s_mov_b64 exec, 1
    ds_add_u32 v4, v5
    s_mov_b64 exec, -1
    v_mov_b32 v4, 96
    s_mov_b32 s65, 0
    s_nop 0
LW_1:
    ds_read_b32 v5, v4
    s_add_u32 s65, s65, 1
    s_cmp_gt_u32 s65, 4000000
    s_cbranch_scc1 L_end
    s_waitcnt lgkmcnt(0)
    v_readfirstlane_b32 s63, v5
    s_nop 0
    s_cmp_lt_u32 s63, 1
    s_nop 2
    s_cbranch_scc1 LW_1
    s_mov_b32 s3, s63
    s_cmp_eq_u32 s3, 1
    s_cbranch_scc1 LFX_2
    buffer_store_dwordx4 v[96:99], v24, s[32:35], s68 offen sc1
    buffer_store_dwordx4 v[100:103], v25, s[32:35], s68 offen sc1
    s_nop 1
LFX_2:
    s_branch L_WO
L_ES2:
    s_mov_b32 s32, s30
    s_mov_b32 s33, s31
    s_mov_b32 s34, 268435456
    s_mov_b32 s35, 0x20000
    s_lshl_b32 s99, s98, 1
    s_add_u32 s99, s99, s56
    s_cmp_ge_u32 s50, 6
    s_cbranch_scc1 L_ES67
    s_getpc_b64 s[44:45]
L_pc1:
    s_sub_u32 s44, s44, L_pc1-L_start
    s_subb_u32 s45, s45, 0
    s_lshl_b32 s57, s99, 7
    s_min_u32 s58, s57, L_end-L_start
    s_load_dword s46, s[44:45], s58
    s_add_u32 s57, s57, 4096
    s_min_u32 s58, s57, L_end-L_start
    s_load_dword s46, s[44:45], s58
    s_add_u32 s57, s57, 4096
    s_min_u32 s58, s57, L_end-L_start
    s_load_dword s46, s[44:45], s58
    s_add_u32 s57, s57, 4096
    s_min_u32 s58, s57, L_end-L_start
    s_load_dword s46, s[44:45], s58
    s_add_u32 s57, s57, 4096
    s_min_u32 s58, s57, L_end-L_start
    s_load_dword s46, s[44:45], s58
    s_add_u32 s57, s57, 4096
    s_min_u32 s58, s57, L_end-L_start
    s_load_dword s46, s[44:45], s58
    s_add_u32 s57, s57, 4096
    s_min_u32 s58, s57, L_end-L_start
    s_load_dword s46, s[44:45], s58
    s_add_u32 s57, s57, 4096
    v_lshlrev_b32 v6, 4, v0
    v_lshrrev_b32 v7, 5, v0
    v_lshlrev_b32 v7, 5, v7
    s_lshl_b32 s59, s48, 5
    s_add_u32 s59, s59, s99
    s_lshl_b32 s60, s59, 9
    s_add_u32 s60, s60, 524288
    s_lshr_b32 s58, s59, 2
    s_lshl_b32 s58, s58, 7
    s_lshl_b32 s59, s59, 11
    s_sub_u32 s58, s58, s59
    s_add_u32 s58, s58, 1048576
    s_add_u32 s59, s59, 1048576
    v_add_u32 v7, s58, v7
    v_mov_b32 v4, 4
    s_mov_b32 s65, 0
    s_nop 0
LW_3:
    ds_read_b32 v5, v4
    s_add_u32 s65, s65, 1
    s_cmp_gt_u32 s65, 4000000
    s_cbranch_scc1 L_end
    s_waitcnt lgkmcnt(0)
    v_readfirstlane_b32 s63, v5
    s_nop 0
    s_cmp_lt_u32 s63, 4
    s_nop 2
    s_cbranch_scc1 LW_3
    buffer_load_dwordx4 v[32:35], v7, s[32:35], s59 offen sc1
    buffer_load_dwordx4 v[36:39], v6, s[32:35], s59 offen sc1
    buffer_load_dwordx4 v[40:43], v6, s[32:35], s59 offen offset:1024 sc1
    s_waitcnt lgkmcnt(0)
    s_add_u32 s51, s64, 1
    s_and_b32 s51, s51, 0xff
    s_or_b32 s51, s51, 0xf00
    v_mov_b32 v3, s51
    s_nop 1
    s_branch L_ESq
L_ES67:
    s_waitcnt lgkmcnt(0)
    s_add_u32 s51, s64, 1
    s_and_b32 s51, s51, 0xff
    s_or_b32 s51, s51, 0xf00
    v_mov_b32 v3, s51
    s_cmp_eq_u32 s50, 7
    s_nop 0
    s_cbranch_scc1 L_ES7
    s_lshl_b32 s59, s48, 14
    s_lshr_b32 s57, s98, 2
    s_lshl_b32 s57, s57, 12
    s_add_u32 s59, s59, s57
    s_add_u32 s59, s59, 262144
    v_mov_b32 v4, 132
    s_mov_b32 s65, 0
    s_nop 0
LW_4:
    ds_read_b32 v5, v4
    s_add_u32 s65, s65, 1
    s_cmp_gt_u32 s65, 4000000
    s_cbranch_scc1 L_end
    s_waitcnt lgkmcnt(0)
    v_readfirstlane_b32 s63, v5
    s_nop 0
    s_cmp_lt_u32 s63, 8
    s_nop 2
    s_cbranch_scc1 LW_4
    s_add_u32 s100, s30, s59
    s_addc_u32 s101, s31, 0
    s_mov_b32 s65, 0
LS_5:
    s_load_dword s62, s[100:101], 0 glc
    s_load_dword s63, s[100:101], 134656 glc
    s_add_u32 s65, s65, 1
    s_cmp_gt_u32 s65, 20000
    s_cbranch_scc1 LSD_6
    s_waitcnt lgkmcnt(0)
    s_xor_b32 s62, s62, s51
    s_xor_b32 s63, s63, s51
    s_or_b32 s62, s62, s63
    s_and_b32 s62, s62, 0xff
    s_cbranch_scc1 LS_5
LSD_6:
    s_waitcnt lgkmcnt(0)
    v_mov_b32 v4, 80
    v_mov_b32 v5, 1
    s_mov_b64 exec, 1
    ds_add_u32 v4, v5
    s_mov_b64 exec, -1
    s_branch L_ESq
L_ES7:
    s_getreg_b32 s61, hwreg(HW_REG_XCC_ID, 0, 4)
    s_add_u32 s56, s64, 1
    s_lshl_b32 s56, s56, 4
    s_or_b32 s61, s61, s56
    s_lshl_b32 s56, s48, 8
    s_lshl_b32 s57, s49, 2
    s_add_u32 s57, s57, s56
    s_add_u32 s57, s57, 16384
    v_mov_b32 v4, s61
    v_mov_b32 v5, 0
    s_mov_b64 exec, 1
    buffer_store_dword v4, v5, s[32:35], s57 offen
    s_mov_b64 exec, -1
    s_lshl_b32 s56, s48, 8
    s_add_u32 s56, s56, 16384
    v_and_b32 v6, 31, v0
    v_lshlrev_b32 v6, 2, v6
    s_mov_b32 s65, 0
    s_mov_b32 s3, 1
LX_7:
    buffer_load_dword v7, v6, s[32:35], s56 offen sc1
    s_add_u32 s65, s65, 1
    s_waitcnt vmcnt(0)
    v_cmp_ne_u32 vcc, s61, v7
    s_nop 4
    s_cbranch_vccz LXD_8
    s_cmp_lt_u32 s65, 48
    s_cbranch_scc1 LX_7
    s_mov_b32 s3, 2
LXD_8:
    v_mov_b32 v4, 96
    v_mov_b32 v5, s3
    s_mov_b64 exec, 1
    ds_write_b32 v4, v5
    s_mov_b64 exec, -1
L_ESq:
    v_and_b32 v6, 7, v1
    v_lshlrev_b32 v6, 9, v6
    v_lshl_add_u32 v6, v2, 5, v6
    v_lshrrev_b32 v4, 3, v1
    v_lshl_add_u32 v6, v4, 4, v6
    s_lshl_b32 s59, s48, 14
    s_lshr_b32 s57, s98, 2
    s_lshl_b32 s57, s57, 12
    s_add_u32 s59, s59, s57
    s_add_u32 s59, s59, 262144
    s_sub_u32 s56, s50, 4
    s_lshl_b32 s57, s56, 7
    s_add_u32 s59, s59, s57
    v_lshlrev_b32 v7, 4, v0
    v_and_b32 v7, 0x37f, v7
    v_lshl_add_u32 v7, v4, 3, v7
    v_bfe_u32 v24, v0, 4, 1
    v_lshl_add_u32 v7, v24, 7, v7
    s_lshl_b32 s57, s56, 10
    v_add_u32 v24, s57, v7
    s_waitcnt vmcnt(0)
    v_mov_b32 v4, 80
    s_mov_b32 s65, 0
    s_nop 0
LW_9:
    ds_read_b32 v5, v4
    s_add_u32 s65, s65, 1
    s_cmp_gt_u32 s65, 4000000
    s_cbranch_scc1 L_end
    s_waitcnt lgkmcnt(0)
    v_readfirstlane_b32 s63, v5
    s_nop 0
    s_cmp_lt_u32 s63, 1
    s_nop 2
    s_cbranch_scc1 LW_9
    s_and_b32 s14, s51, 0xff
    s_mov_b32 s65, 0
    s_add_u32 s66, s59, 131072
LP_11:
    buffer_load_dwordx4 v[8:11], v6, s[32:35], s59 offen sc1
    buffer_load_dwordx4 v[16:19], v6, s[32:35], s66 offen sc1
    s_add_u32 s65, s65, 1
    s_waitcnt vmcnt(1)
    v_xor_b32 v8, s14, v8
    v_xor_b32 v9, s14, v9
    v_xor_b32 v10, s14, v10
    v_xor_b32 v11, s14, v11
    v_or3_b32 v4, v8, v9, v10
    v_or_b32 v4, v4, v11
    s_waitcnt vmcnt(0)
    v_xor_b32 v16, s14, v16
    v_xor_b32 v17, s14, v17
    v_xor_b32 v18, s14, v18
    v_xor_b32 v19, s14, v19
    v_or3_b32 v4, v4, v16, v17
    v_or3_b32 v4, v4, v18, v19
    v_and_b32 v4, 0xff, v4
    v_cmp_ne_u32 vcc, 0, v4
    s_nop 4
    s_cbranch_vccz LD_10
    s_or_b32 exec_lo, vcc_lo, vcc_hi
    s_mov_b32 exec_hi, exec_lo
    s_cmp_lt_u32 s65, 200000
    s_cbranch_scc1 LP_11
    s_branch L_end
LD_10:
    s_mov_b64 exec, -1
    v_add_f32 v8, v8, v16
    v_add_f32 v9, v9, v17
    v_add_f32 v10, v10, v18
    v_add_f32 v11, v11, v19
    v_cvt_pk_bf16_f32 v16, v8, v9
    v_cvt_pk_bf16_f32 v17, v10, v11
    ds_write_b64 v24, v[16:17] offset:2048
    v_mov_b32 v4, 12
    v_mov_b32 v5, 1
    s_mov_b64 exec, 1
    ds_add_u32 v4, v5
    s_mov_b64 exec, -1
    s_branch L_WO
L_OC:
    s_lshl_b32 s99, s98, 1
    v_lshlrev_b32 v6, 4, v0
    v_lshrrev_b32 v7, 5, v0
    v_lshlrev_b32 v7, 5, v7
    s_lshl_b32 s59, s48, 5
    s_add_u32 s59, s59, s99
    s_lshl_b32 s60, s59, 9
    s_add_u32 s60, s60, 524288
    s_lshr_b32 s58, s59, 2
    s_lshl_b32 s58, s58, 7
    s_lshl_b32 s59, s59, 11
    s_sub_u32 s58, s58, s59
    s_add_u32 s58, s58, 1048576
    s_add_u32 s59, s59, 1048576
    v_add_u32 v7, s58, v7
    v_mov_b32 v4, 76
    s_mov_b32 s65, 0
    s_nop 0
LW_12:
    ds_read_b32 v5, v4
    s_add_u32 s65, s65, 1
    s_cmp_gt_u32 s65, 4000000
    s_cbranch_scc1 L_end
    s_waitcnt lgkmcnt(0)
    v_readfirstlane_b32 s63, v5
    s_nop 0
    s_cmp_lt_u32 s63, 8
    s_nop 2
    s_cbranch_scc1 LW_12
    s_and_b32 s14, s51, 0xff
    s_mov_b32 s65, 0
LP_14:
    buffer_load_dwordx4 v[8:11], v7, s[32:35], s59 offen sc1
    buffer_load_dwordx4 v[16:19], v7, s[32:35], s59 offen offset:64 sc1
    buffer_load_dwordx4 v[12:15], v7, s[32:35], s59 offen offset:16 sc1
    buffer_load_dwordx4 v[20:23], v7, s[32:35], s59 offen offset:80 sc1
    s_add_u32 s65, s65, 1
    s_waitcnt vmcnt(3)
    v_xor_b32 v8, v3, v8
    v_xor_b32 v9, v3, v9
    v_xor_b32 v10, v3, v10
    v_xor_b32 v11, v3, v11
    v_or3_b32 v4, v8, v9, v10
    v_or_b32 v4, v4, v11
    s_waitcnt vmcnt(2)
    v_xor_b32 v16, v3, v16
    v_xor_b32 v17, v3, v17
    v_xor_b32 v18, v3, v18
    v_xor_b32 v19, v3, v19
    v_or3_b32 v4, v4, v16, v17
    v_or3_b32 v4, v4, v18, v19
    s_waitcnt vmcnt(1)
    v_xor_b32 v12, s14, v12
    v_xor_b32 v13, s14, v13
    v_xor_b32 v14, s14, v14
    v_xor_b32 v15, s14, v15
    v_or3_b32 v4, v4, v12, v13
    v_or3_b32 v4, v4, v14, v15
    s_waitcnt vmcnt(0)
    v_xor_b32 v20, s14, v20
    v_xor_b32 v21, s14, v21
    v_xor_b32 v22, s14, v22
    v_xor_b32 v23, s14, v23
    v_or3_b32 v4, v4, v20, v21
    v_or3_b32 v4, v4, v22, v23
    v_and_b32 v4, 0xff, v4
    v_cmp_ne_u32 vcc, 0, v4
    s_nop 4
    s_cbranch_vccz LD_13
    s_wqm_b64 exec, vcc
    s_cmp_lt_u32 s65, 200000
    s_cbranch_scc1 LP_14
    s_branch L_end
LD_13:
    s_mov_b64 exec, -1
    s_and_b32 s14, s51, 0xff
    s_mov_b32 s65, 0
    buffer_load_dwordx4 v[96:99], v6, s[32:35], s59 offen sc1
    buffer_load_dwordx4 v[100:103], v6, s[32:35], s59 offen offset:1024 sc1
    buffer_load_dwordx4 v[104:107], v6, s[32:35], s59 offen offset:2048 sc1
    buffer_load_dwordx4 v[108:111], v6, s[32:35], s59 offen offset:3072 sc1
    v_max_f32 v112, v8, v16
    v_max_f32 v113, v9, v17
    v_max_f32 v114, v10, v18
    v_max_f32 v115, v11, v19
    v_mov_b32 v116, v112
    s_nop 1
    v_permlane32_swap_b32 v112, v116
    v_max_f32 v112, v112, v116
    v_mov_b32 v117, v113
    s_nop 1
    v_permlane32_swap_b32 v113, v117
    v_max_f32 v113, v113, v117
    v_mov_b32 v118, v114
    s_nop 1
    v_permlane32_swap_b32 v114, v118
    v_max_f32 v114, v114, v118
    v_mov_b32 v119, v115
    s_nop 1
    v_permlane32_swap_b32 v115, v119
    v_max_f32 v115, v115, v119
    v_sub_f32 v8, v8, v112
    v_mul_f32 v8, 0x3fb8aa3b, v8
    v_exp_f32 v8, v8
    v_sub_f32 v9, v9, v113
    v_mul_f32 v9, 0x3fb8aa3b, v9
    v_exp_f32 v9, v9
    v_sub_f32 v10, v10, v114
    v_mul_f32 v10, 0x3fb8aa3b, v10
    v_exp_f32 v10, v10
    v_sub_f32 v11, v11, v115
    v_mul_f32 v11, 0x3fb8aa3b, v11
    v_exp_f32 v11, v11
    v_sub_f32 v16, v16, v112
    v_mul_f32 v16, 0x3fb8aa3b, v16
    v_exp_f32 v16, v16
    v_sub_f32 v17, v17, v113
    v_mul_f32 v17, 0x3fb8aa3b, v17
    v_exp_f32 v17, v17
    v_sub_f32 v18, v18, v114
    v_mul_f32 v18, 0x3fb8aa3b, v18
    v_exp_f32 v18, v18
    v_sub_f32 v19, v19, v115
    v_mul_f32 v19, 0x3fb8aa3b, v19
    v_exp_f32 v19, v19
    v_mul_f32 v12, v12, v8
    v_mul_f32 v13, v13, v9
    v_mul_f32 v14, v14, v10
    v_mul_f32 v15, v15, v11
    v_fmac_f32 v12, v20, v16
    v_fmac_f32 v13, v21, v17
    v_fmac_f32 v14, v22, v18
    v_fmac_f32 v15, v23, v19
    v_mov_b32 v112, v12
    s_nop 1
    v_permlane32_swap_b32 v12, v112
    v_add_f32 v12, v12, v112
    v_mov_b32 v113, v13
    s_nop 1
    v_permlane32_swap_b32 v13, v113
    v_add_f32 v13, v13, v113
    v_mov_b32 v114, v14
    s_nop 1
    v_permlane32_swap_b32 v14, v114
    v_add_f32 v14, v14, v114
    v_mov_b32 v115, v15
    s_nop 1
    v_permlane32_swap_b32 v15, v115
    v_add_f32 v15, v15, v115
    v_rcp_f32 v12, v12
    v_rcp_f32 v13, v13
    v_rcp_f32 v14, v14
    v_rcp_f32 v15, v15
    s_nop 1
    s_branch LC_17
LP_16:
    buffer_load_dwordx4 v[96:99], v6, s[32:35], s59 offen sc1
    buffer_load_dwordx4 v[100:103], v6, s[32:35], s59 offen offset:1024 sc1
    buffer_load_dwordx4 v[104:107], v6, s[32:35], s59 offen offset:2048 sc1
    buffer_load_dwordx4 v[108:111], v6, s[32:35], s59 offen offset:3072 sc1
LC_17:
    s_add_u32 s65, s65, 1
    s_waitcnt vmcnt(3)
    v_xor_b32 v96, s14, v96
    v_xor_b32 v97, s14, v97
    v_xor_b32 v98, s14, v98
    v_xor_b32 v99, s14, v99
    v_or3_b32 v4, v96, v97, v98
    v_or_b32 v4, v4, v99
    s_waitcnt vmcnt(2)
    v_xor_b32 v100, s14, v100
    v_xor_b32 v101, s14, v101
    v_xor_b32 v102, s14, v102
    v_xor_b32 v103, s14, v103
    v_or3_b32 v4, v4, v100, v101
    v_or3_b32 v4, v4, v102, v103
    s_waitcnt vmcnt(1)
    v_xor_b32 v104, s14, v104
    v_xor_b32 v105, s14, v105
    v_xor_b32 v106, s14, v106
    v_xor_b32 v107, s14, v107
    v_or3_b32 v4, v4, v104, v105
    v_or3_b32 v4, v4, v106, v107
    s_waitcnt vmcnt(0)
    v_xor_b32 v108, s14, v108
    v_xor_b32 v109, s14, v109
    v_xor_b32 v110, s14, v110
    v_xor_b32 v111, s14, v111
    v_or3_b32 v4, v4, v108, v109
    v_or3_b32 v4, v4, v110, v111
    v_and_b32 v4, 0xff, v4
    v_cmp_ne_u32 vcc, 0, v4
    s_nop 4
    s_cbranch_vccz LD_15
    s_wqm_b64 exec, vcc
    s_cmp_lt_u32 s65, 200000
    s_cbranch_scc1 LP_16
    s_branch L_end
LD_15:
    s_mov_b64 exec, -1
    v_pk_mul_f32 v[96:97], v[96:97], v[8:9]
    v_pk_mul_f32 v[98:99], v[98:99], v[10:11]
    v_pk_mul_f32 v[104:105], v[104:105], v[8:9]
    v_pk_mul_f32 v[106:107], v[106:107], v[10:11]
    v_pk_fma_f32 v[96:97], v[100:101], v[16:17], v[96:97]
    v_pk_fma_f32 v[98:99], v[102:103], v[18:19], v[98:99]
    v_pk_fma_f32 v[104:105], v[108:109], v[16:17], v[104:105]
    v_pk_fma_f32 v[106:107], v[110:111], v[18:19], v[106:107]
    s_nop 0
    v_permlane32_swap_b32 v96, v104
    v_permlane32_swap_b32 v97, v105
    v_permlane32_swap_b32 v98, v106
    v_permlane32_swap_b32 v99, v107
    v_pk_add_f32 v[96:97], v[96:97], v[104:105]
    v_pk_add_f32 v[98:99], v[98:99], v[106:107]
    v_pk_mul_f32 v[96:97], v[96:97], v[12:13]
    v_pk_mul_f32 v[98:99], v[98:99], v[14:15]
    v_cvt_pk_bf16_f32 v104, v96, v97
    v_cvt_pk_bf16_f32 v106, v98, v99
    v_lshl_or_b32 v96, v104, 16, v3
    v_and_or_b32 v97, v104, s55, v3
    v_lshl_or_b32 v98, v106, 16, v3
    v_and_or_b32 v99, v106, s55, v3
    buffer_store_dwordx4 v[96:99], v6, s[32:35], s60 offen sc1
    v_mov_b32 v4, 144
    v_mov_b32 v5, 1
    s_mov_b64 exec, 1
    ds_add_u32 v4, v5
    s_mov_b64 exec, -1
    s_branch L_WO2
L_ESst:
    v_and_b32 v7, 7, v0
    v_lshlrev_b32 v6, 5, v7
    s_lshl_b32 s60, s48, 2
    s_lshr_b32 s57, s98, 2
    s_add_u32 s60, s60, s57
    s_lshl_b32 s60, s60, 8
    s_and_b32 s57, s98, 3
    s_lshl_b32 s57, s57, 5
    s_add_u32 s60, s60, s57
    s_add_u32 s60, s60, 2097152
    v_lshrrev_b32 v24, 2, v7
    v_lshlrev_b32 v24, 7, v24
    v_and_b32 v7, 3, v7
    v_lshl_add_u32 v24, v7, 2, v24
    s_mov_b32 s52, 0x1ff
    v_mov_b32 v4, 96
    s_mov_b32 s65, 0
    s_nop 0
LW_18:
    ds_read_b32 v5, v4
    s_add_u32 s65, s65, 1
    s_cmp_gt_u32 s65, 4000000
    s_cbranch_scc1 L_end
    s_waitcnt lgkmcnt(0)
    v_readfirstlane_b32 s63, v5
    s_nop 0
    s_cmp_lt_u32 s63, 1
    s_nop 2
    s_cbranch_scc1 LW_18
    s_mov_b32 s3, s63
    v_mov_b32 v4, 76
    s_mov_b32 s65, 0
    s_nop 0
LW_19:
    ds_read_b32 v5, v4
    s_add_u32 s65, s65, 1
    s_cmp_gt_u32 s65, 4000000
    s_cbranch_scc1 L_end
    s_waitcnt lgkmcnt(0)
    v_readfirstlane_b32 s63, v5
    s_nop 0
    s_cmp_lt_u32 s63, 8
    s_nop 2
    s_cbranch_scc1 LW_19
    ds_read_b128 v[8:11], v6 offset:512
    ds_read_b128 v[12:15], v6 offset:528
    ds_read_b128 v[16:19], v6 offset:768
    ds_read_b128 v[20:23], v6 offset:784
    s_waitcnt lgkmcnt(2)
    v_max3_f32 v8, v8, v9, v10
    v_max3_f32 v11, v11, v12, v13
    v_max3_f32 v8, v8, v14, v15
    v_max_f32 v8, v8, v11
    s_waitcnt lgkmcnt(0)
    v_add_f32 v16, v16, v20
    v_add_f32 v17, v17, v21
    v_add_f32 v18, v18, v22
    v_add_f32 v19, v19, v23
    v_add_f32 v16, v16, v17
    v_add_f32 v18, v18, v19
    v_add_f32 v9, v16, v18
    v_or_b32 v8, v8, v3
    v_bfi_b32 v9, s52, v3, v9
    s_mov_b64 exec, 0xff
    buffer_store_dword v8, v24, s[32:35], s60 offen
    buffer_store_dword v9, v24, s[32:35], s60 offen offset:16
    s_cmp_eq_u32 s3, 1
    s_cbranch_scc1 LFX_20
    buffer_store_dword v8, v24, s[32:35], s60 offen sc1
    buffer_store_dword v9, v24, s[32:35], s60 offen offset:16 sc1
LFX_20:
    s_mov_b64 exec, -1
    s_branch L_WO2
L_FQ2:
    s_mov_b32 s32, s30
    s_mov_b32 s33, s31
    s_mov_b32 s34, 268435456
    s_mov_b32 s35, 0x20000
    s_and_b32 s56, s98, 7
    s_cmp_eq_u32 s56, 3
    s_cbranch_scc1 L_FQ3
    s_waitcnt lgkmcnt(0)
L_FQ3:
    buffer_load_dwordx4 v[64:67], v7, s[36:39], s59 offen offset:0 nt
    s_add_u32 s62, s59, 65536
    buffer_load_dwordx4 v[68:71], v7, s[36:39], s62 offen nt
    s_add_u32 s62, s59, 131072
    buffer_load_dwordx4 v[72:75], v7, s[36:39], s62 offen nt
    s_add_u32 s62, s59, 196608
    buffer_load_dwordx4 v[76:79], v7, s[36:39], s62 offen nt
    s_add_u32 s62, s59, 262144
    buffer_load_dwordx4 v[80:83], v7, s[36:39], s62 offen nt
    s_add_u32 s62, s59, 327680
    buffer_load_dwordx4 v[84:87], v7, s[36:39], s62 offen nt
    s_add_u32 s62, s59, 393216
    buffer_load_dwordx4 v[88:91], v7, s[36:39], s62 offen nt
    s_add_u32 s62, s59, 458752
    buffer_load_dwordx4 v[92:95], v7, s[36:39], s62 offen nt
    s_waitcnt lgkmcnt(0)
    s_add_u32 s51, s64, 1
    s_and_b32 s51, s51, 0xff
    s_or_b32 s51, s51, 0xf00
    v_mov_b32 v3, s51
    v_lshrrev_b32 v5, 3, v1
    v_and_b32 v26, 1, v2
    v_lshl_add_u32 v5, v5, 2, v26
    v_lshlrev_b32 v5, 8, v5
    v_and_b32 v26, 3, v1
    v_lshl_add_u32 v26, v26, 4, v5
    v_bfe_u32 v5, v1, 2, 1
    v_lshl_add_u32 v26, v5, 7, v26
    v_lshrrev_b32 v5, 1, v2
    v_lshl_add_u32 v26, v5, 6, v26
    s_mov_b32 s52, 0x1ff
    v_and_b32 v4, 7, v1
    v_mul_u32_u24 v22, 144, v4
    v_lshrrev_b32 v4, 3, v1
    v_lshl_add_u32 v22, v4, 6, v22
    v_and_b32 v4, 1, v2
    v_mul_u32_u24 v4, 1152, v4
    s_mul_i32 s57, s50, 2304
    v_add3_u32 v22, v22, v4, s57
    v_lshrrev_b32 v4, 1, v2
    v_lshl_add_u32 v22, v4, 5, v22
    v_lshrrev_b32 v4, 3, v0
    v_mul_u32_u24 v23, 144, v4
    v_and_b32 v4, 7, v0
    v_lshl_add_u32 v23, v4, 4, v23
    s_lshr_b32 s57, s50, 2
    s_mul_i32 s57, s57, 1152
    s_and_b32 s56, s50, 3
    s_lshl_b32 s56, s56, 2
    s_add_u32 s57, s57, s56
    s_add_u32 s57, s57, 6144
    v_add_u32 v23, s57, v23
    s_lshl_b32 s59, s58, 11
    s_add_u32 s59, s59, 98304
    s_lshl_b32 s60, s67, 17
    s_lshl_b32 s57, s50, 14
    s_add_u32 s60, s60, s57
    s_lshl_b32 s57, s68, 8
    s_add_u32 s60, s60, s57
    s_add_u32 s60, s60, 262144
    v_lshlrev_b32 v24, 2, v0
    s_waitcnt vmcnt(6)
    v_perm_b32 v32, v68, v64, s53
    v_perm_b32 v36, v68, v64, s54
    v_perm_b32 v40, v69, v65, s53
    v_perm_b32 v44, v69, v65, s54
    v_perm_b32 v48, v70, v66, s53
    v_perm_b32 v52, v70, v66, s54
    v_perm_b32 v56, v71, v67, s53
    v_perm_b32 v60, v71, v67, s54
    s_waitcnt vmcnt(4)
    v_perm_b32 v33, v76, v72, s53
    v_perm_b32 v37, v76, v72, s54
    v_perm_b32 v41, v77, v73, s53
    v_perm_b32 v45, v77, v73, s54
    v_perm_b32 v49, v78, v74, s53
    v_perm_b32 v53, v78, v74, s54
    v_perm_b32 v57, v79, v75, s53
    v_perm_b32 v61, v79, v75, s54
    s_waitcnt vmcnt(2)
    v_perm_b32 v34, v84, v80, s53
    v_perm_b32 v38, v84, v80, s54
    v_perm_b32 v42, v85, v81, s53
    v_perm_b32 v46, v85, v81, s54
    v_perm_b32 v50, v86, v82, s53
    v_perm_b32 v54, v86, v82, s54
    v_perm_b32 v58, v87, v83, s53
    v_perm_b32 v62, v87, v83, s54
    s_waitcnt vmcnt(0)
    v_perm_b32 v35, v92, v88, s53
    v_perm_b32 v39, v92, v88, s54
    v_perm_b32 v43, v93, v89, s53
    v_perm_b32 v47, v93, v89, s54
    v_perm_b32 v51, v94, v90, s53
    v_perm_b32 v55, v94, v90, s54
    v_perm_b32 v59, v95, v91, s53
    v_perm_b32 v63, v95, v91, s54
    v_mov_b32 v64, v32
    v_mov_b32 v65, v33
    v_mov_b32 v66, v34
    v_mov_b32 v67, v35
    v_mov_b32 v68, v36
    v_mov_b32 v69, v37
    v_mov_b32 v70, v38
    v_mov_b32 v71, v39
    v_mov_b32 v72, v40
    v_mov_b32 v73, v41
    v_mov_b32 v74, v42
    v_mov_b32 v75, v43
    v_mov_b32 v76, v44
    v_mov_b32 v77, v45
    v_mov_b32 v78, v46
    v_mov_b32 v79, v47
    v_mov_b32_dpp v32, v48 row_ror:8 row_mask:0xf bank_mask:0xc
    v_mov_b32_dpp v33, v49 row_ror:8 row_mask:0xf bank_mask:0xc
    v_mov_b32_dpp v34, v50 row_ror:8 row_mask:0xf bank_mask:0xc
    v_mov_b32_dpp v35, v51 row_ror:8 row_mask:0xf bank_mask:0xc
    v_mov_b32_dpp v36, v52 row_ror:8 row_mask:0xf bank_mask:0xc
    v_mov_b32_dpp v37, v53 row_ror:8 row_mask:0xf bank_mask:0xc
    v_mov_b32_dpp v38, v54 row_ror:8 row_mask:0xf bank_mask:0xc
    v_mov_b32_dpp v39, v55 row_ror:8 row_mask:0xf bank_mask:0xc
    v_mov_b32_dpp v40, v56 row_ror:8 row_mask:0xf bank_mask:0xc
    v_mov_b32_dpp v41, v57 row_ror:8 row_mask:0xf bank_mask:0xc
    v_mov_b32_dpp v42, v58 row_ror:8 row_mask:0xf bank_mask:0xc
    v_mov_b32_dpp v43, v59 row_ror:8 row_mask:0xf bank_mask:0xc
    v_mov_b32_dpp v44, v60 row_ror:8 row_mask:0xf bank_mask:0xc
    v_mov_b32_dpp v45, v61 row_ror:8 row_mask:0xf bank_mask:0xc
    v_mov_b32_dpp v46, v62 row_ror:8 row_mask:0xf bank_mask:0xc
    v_mov_b32_dpp v47, v63 row_ror:8 row_mask:0xf bank_mask:0xc
    v_mov_b32_dpp v48, v64 row_ror:8 row_mask:0xf bank_mask:0x3
    v_mov_b32_dpp v49, v65 row_ror:8 row_mask:0xf bank_mask:0x3
    v_mov_b32_dpp v50, v66 row_ror:8 row_mask:0xf bank_mask:0x3
    v_mov_b32_dpp v51, v67 row_ror:8 row_mask:0xf bank_mask:0x3
    v_mov_b32_dpp v52, v68 row_ror:8 row_mask:0xf bank_mask:0x3
    v_mov_b32_dpp v53, v69 row_ror:8 row_mask:0xf bank_mask:0x3
    v_mov_b32_dpp v54, v70 row_ror:8 row_mask:0xf bank_mask:0x3
    v_mov_b32_dpp v55, v71 row_ror:8 row_mask:0xf bank_mask:0x3
    v_mov_b32_dpp v56, v72 row_ror:8 row_mask:0xf bank_mask:0x3
    v_mov_b32_dpp v57, v73 row_ror:8 row_mask:0xf bank_mask:0x3
    v_mov_b32_dpp v58, v74 row_ror:8 row_mask:0xf bank_mask:0x3
    v_mov_b32_dpp v59, v75 row_ror:8 row_mask:0xf bank_mask:0x3
    v_mov_b32_dpp v60, v76 row_ror:8 row_mask:0xf bank_mask:0x3
    v_mov_b32_dpp v61, v77 row_ror:8 row_mask:0xf bank_mask:0x3
    v_mov_b32_dpp v62, v78 row_ror:8 row_mask:0xf bank_mask:0x3
    v_mov_b32_dpp v63, v79 row_ror:8 row_mask:0xf bank_mask:0x3
    v_mov_b32 v4, 8
    s_mov_b32 s65, 0
    s_nop 0
LW_21:
    ds_read_b32 v5, v4
    s_add_u32 s65, s65, 1
    s_cmp_gt_u32 s65, 4000000
    s_cbranch_scc1 L_end
    s_waitcnt lgkmcnt(0)
    v_readfirstlane_b32 s63, v5
    s_nop 0
    s_cmp_lt_u32 s63, 2
    s_nop 2
    s_cbranch_scc1 LW_21
    s_mov_b32 s65, 0
LP_23:
    buffer_load_dwordx4 v[8:11], v26, s[32:35], s59 offen sc1
    buffer_load_dwordx4 v[12:15], v26, s[32:35], s59 offen offset:512 sc1
    s_add_u32 s65, s65, 1
    s_waitcnt vmcnt(1)
    v_xor_b32 v8, v3, v8
    v_xor_b32 v9, v3, v9
    v_xor_b32 v10, v3, v10
    v_xor_b32 v11, v3, v11
    v_or3_b32 v4, v8, v9, v10
    v_or_b32 v4, v4, v11
    s_waitcnt vmcnt(0)
    v_xor_b32 v12, v3, v12
    v_xor_b32 v13, v3, v13
    v_xor_b32 v14, v3, v14
    v_xor_b32 v15, v3, v15
    v_or3_b32 v4, v4, v12, v13
    v_or3_b32 v4, v4, v14, v15
    v_and_b32 v4, 0xffff, v4
    v_cmp_ne_u32 vcc, 0, v4
    s_nop 4
    s_cbranch_vccz LD_22
    s_mov_b64 exec, vcc
    s_cmp_lt_u32 s65, 200000
    s_cbranch_scc1 LP_23
    s_branch L_end
LD_22:
    s_mov_b64 exec, -1
    v_perm_b32 v16, v9, v8, s54
    v_perm_b32 v17, v11, v10, s54
    v_perm_b32 v18, v13, v12, s54
    v_perm_b32 v19, v15, v14, s54
    s_nop 0
    v_permlane32_swap_b32 v16, v18
    v_permlane32_swap_b32 v17, v19
    s_nop 1
    v_mfma_f32_16x16x32_bf16 v[96:99], v[16:19], v[32:35], 0
    v_mov_b32_dpp v8, v16 row_ror:8 row_mask:0xf bank_mask:0xf
    v_mfma_f32_16x16x32_bf16 v[100:103], v[16:19], v[36:39], 0
    v_mov_b32_dpp v9, v17 row_ror:8 row_mask:0xf bank_mask:0xf
    v_mfma_f32_16x16x32_bf16 v[104:107], v[16:19], v[40:43], 0
    v_mov_b32_dpp v10, v18 row_ror:8 row_mask:0xf bank_mask:0xf
    v_mfma_f32_16x16x32_bf16 v[108:111], v[16:19], v[44:47], 0
    v_mov_b32_dpp v11, v19 row_ror:8 row_mask:0xf bank_mask:0xf
    s_nop 1
    v_mfma_f32_16x16x32_bf16 v[96:99], v[8:11], v[48:51], v[96:99]
    v_mfma_f32_16x16x32_bf16 v[104:107], v[8:11], v[56:59], v[104:107]
    v_mfma_f32_16x16x32_bf16 v[100:103], v[8:11], v[52:55], v[100:103]
    v_mfma_f32_16x16x32_bf16 v[108:111], v[8:11], v[60:63], v[108:111]
    s_nop 5
    v_permlane32_swap_b32 v96, v104
    v_permlane32_swap_b32 v97, v105
    v_permlane32_swap_b32 v98, v106
    v_permlane32_swap_b32 v99, v107
    ds_write_b128 v22, v[96:99] offset:6144
    v_permlane32_swap_b32 v100, v108
    v_permlane32_swap_b32 v101, v109
    v_permlane32_swap_b32 v102, v110
    v_permlane32_swap_b32 v103, v111
    ds_write_b128 v22, v[100:103] offset:6160
    v_mov_b32 v4, 24
    v_mov_b32 v5, 1
    s_mov_b64 exec, 1
    ds_add_u32 v4, v5
    s_mov_b64 exec, -1
    v_mov_b32 v4, 24
    s_mov_b32 s65, 0
    s_nop 0
LW_24:
    ds_read_b32 v5, v4
    s_add_u32 s65, s65, 1
    s_cmp_gt_u32 s65, 4000000
    s_cbranch_scc1 L_end
    s_waitcnt lgkmcnt(0)
    v_readfirstlane_b32 s63, v5
    s_nop 0
    s_cmp_lt_u32 s63, 8
    s_nop 2
    s_cbranch_scc1 LW_24
    ds_read2st64_b32 v[32:33], v23 offset0:0 offset1:9
    ds_read2st64_b32 v[34:35], v23 offset0:18 offset1:27
    ds_read2st64_b32 v[36:37], v23 offset0:36 offset1:45
    ds_read2st64_b32 v[38:39], v23 offset0:54 offset1:63
    s_waitcnt lgkmcnt(2)
    v_pk_add_f32 v[32:33], v[32:33], v[34:35]
    s_waitcnt lgkmcnt(0)
    v_pk_add_f32 v[36:37], v[36:37], v[38:39]
    v_pk_add_f32 v[32:33], v[32:33], v[36:37]
    v_add_f32 v36, v32, v33
    v_bfi_b32 v36, s52, v3, v36
    s_nop 1
    v_mov_b32_dpp v32, v36 quad_perm:[0,0,0,0] row_mask:0xf bank_mask:0xf
    v_mov_b32_dpp v33, v36 quad_perm:[1,1,1,1] row_mask:0xf bank_mask:0xf
    v_mov_b32_dpp v34, v36 quad_perm:[2,2,2,2] row_mask:0xf bank_mask:0xf
    v_mov_b32_dpp v35, v36 quad_perm:[3,3,3,3] row_mask:0xf bank_mask:0xf
    s_mov_b32 exec_lo, 0x11111111
    s_mov_b32 exec_hi, 0x11111111
    buffer_store_dwordx4 v[32:35], v24, s[32:35], s60 offen sc1
    s_mov_b64 exec, -1
    v_mov_b32 v4, 36
    v_mov_b32 v5, 1
    s_mov_b64 exec, 1
    ds_add_u32 v4, v5
    s_mov_b64 exec, -1
    s_branch L_F2
L_FM:
    s_mov_b32 s32, s30
    s_mov_b32 s33, s31
    s_mov_b32 s34, 268435456
    s_mov_b32 s35, 0x20000
    s_cmp_ge_u32 s50, 12
    s_cbranch_scc1 L_FW
    s_cmp_eq_u32 s50, 11
    s_cselect_b32 s56, 14, 0
    s_add_u32 s98, s98, s56
    s_and_b32 s98, s98, 15
    s_mov_b32 s40, s22
    s_mov_b32 s41, s23
    s_mov_b32 s42, 16384
    s_mov_b32 s43, 0x20000
    v_lshrrev_b32 v5, 3, v1
    v_lshl_add_u32 v5, v5, 2, v2
    v_lshlrev_b32 v5, 4, v5
    v_and_b32 v6, 7, v1
    s_mov_b32 s62, 2048
    v_mul_lo_u32 v6, v6, s62
    v_add_u32 v6, v6, v5
    s_lshl_b32 s60, s98, 7
    buffer_load_dwordx4 v[8:11], v6, s[40:43], s60 offen
    s_mov_b32 s36, s24
    s_mov_b32 s37, s25
    s_mov_b32 s38, 12582912
    s_mov_b32 s39, 0x20000
    s_waitcnt vmcnt(1)
    s_mov_b32 s56, 0x3f803f80
    v_dot2_f32_bf16 v4, v32, s56, 0
    v_dot2_f32_bf16 v6, v32, v32, 0
    v_dot2_f32_bf16 v5, v33, s56, 0
    v_dot2_f32_bf16 v7, v33, v33, 0
    v_dot2_f32_bf16 v4, v34, s56, v4
    v_dot2_f32_bf16 v6, v34, v34, v6
    v_dot2_f32_bf16 v5, v35, s56, v5
    v_dot2_f32_bf16 v7, v35, v35, v7
    v_dot2_f32_bf16 v4, v36, s56, v4
    v_dot2_f32_bf16 v6, v36, v36, v6
    v_dot2_f32_bf16 v5, v37, s56, v5
    v_dot2_f32_bf16 v7, v37, v37, v7
    v_dot2_f32_bf16 v4, v38, s56, v4
    v_dot2_f32_bf16 v6, v38, v38, v6
    v_dot2_f32_bf16 v5, v39, s56, v5
    v_dot2_f32_bf16 v7, v39, v39, v7
    v_dot2_f32_bf16 v4, v40, s56, v4
    v_dot2_f32_bf16 v6, v40, v40, v6
    v_dot2_f32_bf16 v5, v41, s56, v5
    v_dot2_f32_bf16 v7, v41, v41, v7
    v_dot2_f32_bf16 v4, v42, s56, v4
    v_dot2_f32_bf16 v6, v42, v42, v6
    v_dot2_f32_bf16 v5, v43, s56, v5
    v_dot2_f32_bf16 v7, v43, v43, v7
    v_dot2_f32_bf16 v4, v44, s56, v4
    v_dot2_f32_bf16 v6, v44, v44, v6
    v_dot2_f32_bf16 v5, v45, s56, v5
    v_dot2_f32_bf16 v7, v45, v45, v7
    v_dot2_f32_bf16 v4, v46, s56, v4
    v_dot2_f32_bf16 v6, v46, v46, v6
    v_dot2_f32_bf16 v5, v47, s56, v5
    v_dot2_f32_bf16 v7, v47, v47, v7
    s_nop 2
    v_add_f32 v4, v4, v5
    v_add_f32 v5, v6, v7
    s_nop 0
    v_add_f32_dpp v4, v4, v4 quad_perm:[1,0,3,2] row_mask:0xf bank_mask:0xf
    v_add_f32_dpp v5, v5, v5 quad_perm:[1,0,3,2] row_mask:0xf bank_mask:0xf
    s_nop 0
    v_add_f32_dpp v4, v4, v4 quad_perm:[2,3,0,1] row_mask:0xf bank_mask:0xf
    v_add_f32_dpp v5, v5, v5 quad_perm:[2,3,0,1] row_mask:0xf bank_mask:0xf
    s_nop 0
    v_add_f32_dpp v4, v4, v4 row_half_mirror row_mask:0xf bank_mask:0xf
    v_add_f32_dpp v5, v5, v5 row_half_mirror row_mask:0xf bank_mask:0xf
    s_nop 0
    v_add_f32_dpp v4, v4, v4 row_ror:8 row_mask:0xf bank_mask:0xf
    v_add_f32_dpp v5, v5, v5 row_ror:8 row_mask:0xf bank_mask:0xf
    s_nop 1
    v_permlane16_swap_b32 v4, v5
    v_add_f32 v4, v4, v5
    v_mul_f32 v4, 0x3a800000, v4
    v_mov_b32 v5, v4
    s_nop 1
    v_permlane16_swap_b32 v4, v5
    v_fma_f32 v5, -v4, v4, v5
    v_max_f32 v5, 0, v5
    v_cvt_pk_bf16_f32 v6, v4, v5
    v_lshlrev_b32 v4, 16, v6
    v_and_b32 v5, 0xffff0000, v6
    v_add_f32 v5, 0x3727c5ac, v5
    v_cvt_pk_bf16_f32 v5, v5, v5
    v_and_b32 v5, 0xffff0000, v5
    v_sqrt_f32 v5, v5
    s_nop 0
    v_cvt_pk_bf16_f32 v5, v5, v5
    v_and_b32 v5, 0xffff0000, v5
    v_rcp_f32 v6, v5
    s_nop 0
    v_fma_f32 v5, -v5, v6, 1.0
    v_fma_f32 v5, v5, v6, v6
    s_sub_u32 s56, s50, 8
    s_lshl_b32 s56, s56, 4
    v_lshrrev_b32 v6, 5, v0
    v_lshlrev_b32 v6, 3, v6
    v_add_u32 v6, s56, v6
    s_mov_b32 exec_lo, 1
    s_mov_b32 exec_hi, 1
    ds_write_b64 v6, v[4:5] offset:256
    s_mov_b64 exec, -1
    v_mov_b32 v4, 0
    v_mov_b32 v5, 1
    s_mov_b64 exec, 1
    ds_add_u32 v4, v5
    s_mov_b64 exec, -1
    s_sub_u32 s56, s50, 8
    s_cmp_eq_u32 s50, 9
    s_cselect_b32 s59, 1, 0
    s_lshr_b32 s58, s56, 1
    s_sub_u32 s58, 2, s58
    s_lshl_b32 s57, s56, 2
    s_lshr_b32 s57, 0x2243, s57
    s_and_b32 s57, s57, 15
    s_mul_i32 s67, s98, 786432
    s_lshl_b32 s60, s48, 8
    s_add_u32 s67, s67, s60
    s_lshl_b32 s60, s57, 11
    s_add_u32 s67, s67, s60
    s_lshl_b32 s68, s58, 20
    s_lshl_b32 s60, s48, 17
    s_add_u32 s68, s68, s60
    s_add_u32 s68, s68, 3145728
    s_lshl_b32 s60, s59, 11
    s_add_u32 s68, s68, s60
    s_lshl_b32 s60, s98, 7
    s_add_u32 s68, s68, s60
    s_add_u32 s69, s68, 0x10000
    s_and_b32 s98, s49, 15
    v_lshrrev_b32 v5, 3, v1
    v_lshl_add_u32 v5, v5, 2, v2
    s_mov_b32 s62, 98304
    v_mul_lo_u32 v5, v5, s62
    v_and_b32 v7, 7, v1
    v_lshl_add_u32 v7, v7, 4, v5
    v_add_u32 v27, 128, v7
    s_mov_b32 s52, 0x1ff
    v_lshlrev_b32 v26, 4, v0
    v_lshrrev_b32 v4, 3, v1
    v_lshrrev_b32 v5, 1, v2
    v_lshl_add_u32 v4, v5, 1, v4
    v_and_b32 v5, 1, v2
    v_lshl_add_u32 v4, v4, 2, v5
    v_lshlrev_b32 v24, 12, v4
    v_and_b32 v4, 7, v1
    v_lshl_add_u32 v24, v4, 4, v24
    v_add_u32 v25, 0x2000, v24
    s_waitcnt lgkmcnt(0)
    s_add_u32 s51, s64, 1
    s_and_b32 s51, s51, 0xff
    s_or_b32 s51, s51, 0xf00
    v_mov_b32 v3, s51
    s_waitcnt vmcnt(0)
    v_lshlrev_b32 v12, 16, v8
    v_and_b32 v13, 0xffff0000, v8
    v_lshlrev_b32 v14, 16, v9
    v_and_b32 v15, 0xffff0000, v9
    v_lshlrev_b32 v16, 16, v10
    v_and_b32 v17, 0xffff0000, v10
    v_lshlrev_b32 v18, 16, v11
    v_and_b32 v19, 0xffff0000, v11
    v_mul_f32 v4, 0xbfb8aa3b, v12
    v_exp_f32 v4, v4
    s_nop 0
    v_add_f32 v4, 1.0, v4
    v_rcp_f32 v4, v4
    s_nop 0
    v_mul_f32 v12, v12, v4
    v_mul_f32 v5, 0xbfb8aa3b, v13
    v_exp_f32 v5, v5
    s_nop 0
    v_add_f32 v5, 1.0, v5
    v_rcp_f32 v5, v5
    s_nop 0
    v_mul_f32 v13, v13, v5
    v_mul_f32 v4, 0xbfb8aa3b, v14
    v_exp_f32 v4, v4
    s_nop 0
    v_add_f32 v4, 1.0, v4
    v_rcp_f32 v4, v4
    s_nop 0
    v_mul_f32 v14, v14, v4
    v_mul_f32 v5, 0xbfb8aa3b, v15
    v_exp_f32 v5, v5
    s_nop 0
    v_add_f32 v5, 1.0, v5
    v_rcp_f32 v5, v5
    s_nop 0
    v_mul_f32 v15, v15, v5
    v_mul_f32 v4, 0xbfb8aa3b, v16
    v_exp_f32 v4, v4
    s_nop 0
    v_add_f32 v4, 1.0, v4
    v_rcp_f32 v4, v4
    s_nop 0
    v_mul_f32 v16, v16, v4
    v_mul_f32 v5, 0xbfb8aa3b, v17
    v_exp_f32 v5, v5
    s_nop 0
    v_add_f32 v5, 1.0, v5
    v_rcp_f32 v5, v5
    s_nop 0
    v_mul_f32 v17, v17, v5
    v_mul_f32 v4, 0xbfb8aa3b, v18
    v_exp_f32 v4, v4
    s_nop 0
    v_add_f32 v4, 1.0, v4
    v_rcp_f32 v4, v4
    s_nop 0
    v_mul_f32 v18, v18, v4
    v_mul_f32 v5, 0xbfb8aa3b, v19
    v_exp_f32 v5, v5
    s_nop 0
    v_add_f32 v5, 1.0, v5
    v_rcp_f32 v5, v5
    s_nop 0
    v_mul_f32 v19, v19, v5
    v_cvt_pk_bf16_f32 v28, v12, v13
    v_cvt_pk_bf16_f32 v29, v14, v15
    v_cvt_pk_bf16_f32 v30, v16, v17
    v_cvt_pk_bf16_f32 v31, v18, v19
    v_mov_b32 v4, 96
    s_mov_b32 s65, 0
    s_nop 0
LW_25:
    ds_read_b32 v5, v4
    s_add_u32 s65, s65, 1
    s_cmp_gt_u32 s65, 4000000
    s_cbranch_scc1 L_end
    s_waitcnt lgkmcnt(0)
    v_readfirstlane_b32 s63, v5
    s_nop 0
    s_cmp_lt_u32 s63, 1
    s_nop 2
    s_cbranch_scc1 LW_25
    s_mov_b32 s3, s63
    s_cmp_ge_u32 s50, 10
    s_cbranch_scc1 L_FMga
    v_mov_b32 v4, 24
    s_mov_b32 s65, 0
    s_nop 0
LW_26:
    ds_read_b32 v5, v4
    s_add_u32 s65, s65, 1
    s_cmp_gt_u32 s65, 4000000
    s_cbranch_scc1 L_end
    s_waitcnt lgkmcnt(0)
    v_readfirstlane_b32 s63, v5
    s_nop 0
    s_cmp_lt_u32 s63, 8
    s_nop 2
    s_cbranch_scc1 LW_26
    buffer_load_dwordx4 v[64:67], v7, s[36:39], s67 offen offset:0 nt
    s_add_u32 s62, s67, 12288
    buffer_load_dwordx4 v[68:71], v7, s[36:39], s62 offen nt
    s_add_u32 s62, s67, 24576
    buffer_load_dwordx4 v[72:75], v7, s[36:39], s62 offen nt
    s_add_u32 s62, s67, 36864
    buffer_load_dwordx4 v[76:79], v7, s[36:39], s62 offen nt
    s_add_u32 s62, s67, 49152
    buffer_load_dwordx4 v[80:83], v7, s[36:39], s62 offen nt
    s_add_u32 s62, s67, 61440
    buffer_load_dwordx4 v[84:87], v7, s[36:39], s62 offen nt
    s_add_u32 s62, s67, 73728
    buffer_load_dwordx4 v[88:91], v7, s[36:39], s62 offen nt
    s_add_u32 s62, s67, 86016
    buffer_load_dwordx4 v[92:95], v7, s[36:39], s62 offen nt
    buffer_load_dwordx4 v[96:99], v27, s[36:39], s67 offen offset:0 nt
    s_add_u32 s62, s67, 12288
    buffer_load_dwordx4 v[100:103], v27, s[36:39], s62 offen nt
    s_add_u32 s62, s67, 24576
    buffer_load_dwordx4 v[104:107], v27, s[36:39], s62 offen nt
    s_add_u32 s62, s67, 36864
    buffer_load_dwordx4 v[108:111], v27, s[36:39], s62 offen nt
    s_add_u32 s62, s67, 49152
    buffer_load_dwordx4 v[112:115], v27, s[36:39], s62 offen nt
    s_add_u32 s62, s67, 61440
    buffer_load_dwordx4 v[116:119], v27, s[36:39], s62 offen nt
    s_add_u32 s62, s67, 73728
    buffer_load_dwordx4 v[120:123], v27, s[36:39], s62 offen nt
    s_add_u32 s62, s67, 86016
    buffer_load_dwordx4 v[124:127], v27, s[36:39], s62 offen nt
    s_waitcnt vmcnt(14)
    v_perm_b32 v32, v68, v64, s53
    v_perm_b32 v36, v68, v64, s54
    v_perm_b32 v40, v69, v65, s53
    v_perm_b32 v44, v69, v65, s54
    v_perm_b32 v48, v70, v66, s53
    v_perm_b32 v52, v70, v66, s54
    v_perm_b32 v56, v71, v67, s53
    v_perm_b32 v60, v71, v67, s54
    s_waitcnt vmcnt(12)
    v_perm_b32 v33, v76, v72, s53
    v_perm_b32 v37, v76, v72, s54
    v_perm_b32 v41, v77, v73, s53
    v_perm_b32 v45, v77, v73, s54
    v_perm_b32 v49, v78, v74, s53
    v_perm_b32 v53, v78, v74, s54
    v_perm_b32 v57, v79, v75, s53
    v_perm_b32 v61, v79, v75, s54
    s_waitcnt vmcnt(10)
    v_perm_b32 v34, v84, v80, s53
    v_perm_b32 v38, v84, v80, s54
    v_perm_b32 v42, v85, v81, s53
    v_perm_b32 v46, v85, v81, s54
    v_perm_b32 v50, v86, v82, s53
    v_perm_b32 v54, v86, v82, s54
    v_perm_b32 v58, v87, v83, s53
    v_perm_b32 v62, v87, v83, s54
    s_waitcnt vmcnt(8)
    v_perm_b32 v35, v92, v88, s53
    v_perm_b32 v39, v92, v88, s54
    v_perm_b32 v43, v93, v89, s53
    v_perm_b32 v47, v93, v89, s54
    v_perm_b32 v51, v94, v90, s53
    v_perm_b32 v55, v94, v90, s54
    v_perm_b32 v59, v95, v91, s53
    v_perm_b32 v63, v95, v91, s54
    v_mfma_f32_16x16x32_bf16 v[64:67], v[28:31], v[32:35], 0
    v_mfma_f32_16x16x32_bf16 v[68:71], v[28:31], v[36:39], 0
    v_mfma_f32_16x16x32_bf16 v[72:75], v[28:31], v[40:43], 0
    v_mfma_f32_16x16x32_bf16 v[76:79], v[28:31], v[44:47], 0
    v_mfma_f32_16x16x32_bf16 v[80:83], v[28:31], v[48:51], 0
    v_mfma_f32_16x16x32_bf16 v[84:87], v[28:31], v[52:55], 0
    v_mfma_f32_16x16x32_bf16 v[88:91], v[28:31], v[56:59], 0
    v_mfma_f32_16x16x32_bf16 v[92:95], v[28:31], v[60:63], 0
    s_nop 4
    v_permlane32_swap_b32 v64, v80
    v_permlane32_swap_b32 v65, v81
    v_permlane32_swap_b32 v66, v82
    v_permlane32_swap_b32 v67, v83
    v_permlane32_swap_b32 v68, v84
    v_permlane32_swap_b32 v69, v85
    v_permlane32_swap_b32 v70, v86
    v_permlane32_swap_b32 v71, v87
    v_permlane32_swap_b32 v72, v88
    v_permlane32_swap_b32 v73, v89
    v_permlane32_swap_b32 v74, v90
    v_permlane32_swap_b32 v75, v91
    v_permlane32_swap_b32 v76, v92
    v_permlane32_swap_b32 v77, v93
    v_permlane32_swap_b32 v78, v94
    v_permlane32_swap_b32 v79, v95
    v_add_f32_dpp v64, v80, v64 row_ror:8 row_mask:0xf bank_mask:0xf
    v_add_f32_dpp v65, v81, v65 row_ror:8 row_mask:0xf bank_mask:0xf
    v_add_f32_dpp v66, v82, v66 row_ror:8 row_mask:0xf bank_mask:0xf
    v_add_f32_dpp v67, v83, v67 row_ror:8 row_mask:0xf bank_mask:0xf
    v_add_f32_dpp v68, v84, v68 row_ror:8 row_mask:0xf bank_mask:0xf
    v_add_f32_dpp v69, v85, v69 row_ror:8 row_mask:0xf bank_mask:0xf
    v_add_f32_dpp v70, v86, v70 row_ror:8 row_mask:0xf bank_mask:0xf
    v_add_f32_dpp v71, v87, v71 row_ror:8 row_mask:0xf bank_mask:0xf
    v_add_f32_dpp v72, v88, v72 row_ror:8 row_mask:0xf bank_mask:0xf
    v_add_f32_dpp v73, v89, v73 row_ror:8 row_mask:0xf bank_mask:0xf
    v_add_f32_dpp v74, v90, v74 row_ror:8 row_mask:0xf bank_mask:0xf
    v_add_f32_dpp v75, v91, v75 row_ror:8 row_mask:0xf bank_mask:0xf
    v_add_f32_dpp v76, v92, v76 row_ror:8 row_mask:0xf bank_mask:0xf
    v_add_f32_dpp v77, v93, v77 row_ror:8 row_mask:0xf bank_mask:0xf
    v_add_f32_dpp v78, v94, v78 row_ror:8 row_mask:0xf bank_mask:0xf
    v_add_f32_dpp v79, v95, v79 row_ror:8 row_mask:0xf bank_mask:0xf
    v_mov_b32_dpp v64, v72 row_ror:8 row_mask:0xf bank_mask:0xc
    v_mov_b32_dpp v65, v73 row_ror:8 row_mask:0xf bank_mask:0xc
    v_mov_b32_dpp v66, v74 row_ror:8 row_mask:0xf bank_mask:0xc
    v_mov_b32_dpp v67, v75 row_ror:8 row_mask:0xf bank_mask:0xc
    v_mov_b32_dpp v68, v76 row_ror:8 row_mask:0xf bank_mask:0xc
    v_mov_b32_dpp v69, v77 row_ror:8 row_mask:0xf bank_mask:0xc
    v_mov_b32_dpp v70, v78 row_ror:8 row_mask:0xf bank_mask:0xc
    v_mov_b32_dpp v71, v79 row_ror:8 row_mask:0xf bank_mask:0xc
    v_bfi_b32 v64, s52, v3, v64
    v_bfi_b32 v65, s52, v3, v65
    v_bfi_b32 v66, s52, v3, v66
    v_bfi_b32 v67, s52, v3, v67
    v_bfi_b32 v68, s52, v3, v68
    v_bfi_b32 v69, s52, v3, v69
    v_bfi_b32 v70, s52, v3, v70
    v_bfi_b32 v71, s52, v3, v71
    s_waitcnt vmcnt(6)
    v_perm_b32 v32, v100, v96, s53
    v_perm_b32 v36, v100, v96, s54
    v_perm_b32 v40, v101, v97, s53
    v_perm_b32 v44, v101, v97, s54
    v_perm_b32 v48, v102, v98, s53
    v_perm_b32 v52, v102, v98, s54
    v_perm_b32 v56, v103, v99, s53
    v_perm_b32 v60, v103, v99, s54
    s_waitcnt vmcnt(4)
    v_perm_b32 v33, v108, v104, s53
    v_perm_b32 v37, v108, v104, s54
    v_perm_b32 v41, v109, v105, s53
    v_perm_b32 v45, v109, v105, s54
    v_perm_b32 v49, v110, v106, s53
    v_perm_b32 v53, v110, v106, s54
    v_perm_b32 v57, v111, v107, s53
    v_perm_b32 v61, v111, v107, s54
    s_waitcnt vmcnt(2)
    v_perm_b32 v34, v116, v112, s53
    v_perm_b32 v38, v116, v112, s54
    v_perm_b32 v42, v117, v113, s53
    v_perm_b32 v46, v117, v113, s54
    v_perm_b32 v50, v118, v114, s53
    v_perm_b32 v54, v118, v114, s54
    v_perm_b32 v58, v119, v115, s53
    v_perm_b32 v62, v119, v115, s54
    s_waitcnt vmcnt(0)
    v_perm_b32 v35, v124, v120, s53
    v_perm_b32 v39, v124, v120, s54
    v_perm_b32 v43, v125, v121, s53
    v_perm_b32 v47, v125, v121, s54
    v_perm_b32 v51, v126, v122, s53
    v_perm_b32 v55, v126, v122, s54
    v_perm_b32 v59, v127, v123, s53
    v_perm_b32 v63, v127, v123, s54
    buffer_store_dwordx4 v[64:67], v24, s[32:35], s68 offen
    buffer_store_dwordx4 v[68:71], v25, s[32:35], s68 offen
    v_mfma_f32_16x16x32_bf16 v[96:99], v[28:31], v[32:35], 0
    v_mfma_f32_16x16x32_bf16 v[100:103], v[28:31], v[36:39], 0
    v_mfma_f32_16x16x32_bf16 v[104:107], v[28:31], v[40:43], 0
    v_mfma_f32_16x16x32_bf16 v[108:111], v[28:31], v[44:47], 0
    v_mfma_f32_16x16x32_bf16 v[112:115], v[28:31], v[48:51], 0
    v_mfma_f32_16x16x32_bf16 v[116:119], v[28:31], v[52:55], 0
    v_mfma_f32_16x16x32_bf16 v[120:123], v[28:31], v[56:59], 0
    v_mfma_f32_16x16x32_bf16 v[124:127], v[28:31], v[60:63], 0
    s_nop 4
    v_permlane32_swap_b32 v96, v112
    v_permlane32_swap_b32 v97, v113
    v_permlane32_swap_b32 v98, v114
    v_permlane32_swap_b32 v99, v115
    v_permlane32_swap_b32 v100, v116
    v_permlane32_swap_b32 v101, v117
    v_permlane32_swap_b32 v102, v118
    v_permlane32_swap_b32 v103, v119
    v_permlane32_swap_b32 v104, v120
    v_permlane32_swap_b32 v105, v121
    v_permlane32_swap_b32 v106, v122
    v_permlane32_swap_b32 v107, v123
    v_permlane32_swap_b32 v108, v124
    v_permlane32_swap_b32 v109, v125
    v_permlane32_swap_b32 v110, v126
    v_permlane32_swap_b32 v111, v127
    v_add_f32_dpp v96, v112, v96 row_ror:8 row_mask:0xf bank_mask:0xf
    v_add_f32_dpp v97, v113, v97 row_ror:8 row_mask:0xf bank_mask:0xf
    v_add_f32_dpp v98, v114, v98 row_ror:8 row_mask:0xf bank_mask:0xf
    v_add_f32_dpp v99, v115, v99 row_ror:8 row_mask:0xf bank_mask:0xf
    v_add_f32_dpp v100, v116, v100 row_ror:8 row_mask:0xf bank_mask:0xf
    v_add_f32_dpp v101, v117, v101 row_ror:8 row_mask:0xf bank_mask:0xf
    v_add_f32_dpp v102, v118, v102 row_ror:8 row_mask:0xf bank_mask:0xf
    v_add_f32_dpp v103, v119, v103 row_ror:8 row_mask:0xf bank_mask:0xf
    v_add_f32_dpp v104, v120, v104 row_ror:8 row_mask:0xf bank_mask:0xf
    v_add_f32_dpp v105, v121, v105 row_ror:8 row_mask:0xf bank_mask:0xf
    v_add_f32_dpp v106, v122, v106 row_ror:8 row_mask:0xf bank_mask:0xf
    v_add_f32_dpp v107, v123, v107 row_ror:8 row_mask:0xf bank_mask:0xf
    v_add_f32_dpp v108, v124, v108 row_ror:8 row_mask:0xf bank_mask:0xf
    v_add_f32_dpp v109, v125, v109 row_ror:8 row_mask:0xf bank_mask:0xf
    v_add_f32_dpp v110, v126, v110 row_ror:8 row_mask:0xf bank_mask:0xf
    v_add_f32_dpp v111, v127, v111 row_ror:8 row_mask:0xf bank_mask:0xf
    v_mov_b32_dpp v96, v104 row_ror:8 row_mask:0xf bank_mask:0xc
    v_mov_b32_dpp v97, v105 row_ror:8 row_mask:0xf bank_mask:0xc
    v_mov_b32_dpp v98, v106 row_ror:8 row_mask:0xf bank_mask:0xc
    v_mov_b32_dpp v99, v107 row_ror:8 row_mask:0xf bank_mask:0xc
    v_mov_b32_dpp v100, v108 row_ror:8 row_mask:0xf bank_mask:0xc
    v_mov_b32_dpp v101, v109 row_ror:8 row_mask:0xf bank_mask:0xc
    v_mov_b32_dpp v102, v110 row_ror:8 row_mask:0xf bank_mask:0xc
    v_mov_b32_dpp v103, v111 row_ror:8 row_mask:0xf bank_mask:0xc
    v_bfi_b32 v96, s52, v3, v96
    v_bfi_b32 v97, s52, v3, v97
    v_bfi_b32 v98, s52, v3, v98
    v_bfi_b32 v99, s52, v3, v99
    v_bfi_b32 v100, s52, v3, v100
    v_bfi_b32 v101, s52, v3, v101
    v_bfi_b32 v102, s52, v3, v102
    v_bfi_b32 v103, s52, v3, v103
    buffer_store_dwordx4 v[96:99], v24, s[32:35], s69 offen
    buffer_store_dwordx4 v[100:103], v25, s[32:35], s69 offen
    s_cmp_eq_u32 s3, 1
    s_nop 0
    s_cbranch_scc1 LFX_27
    buffer_store_dwordx4 v[64:67], v24, s[32:35], s68 offen sc1
    buffer_store_dwordx4 v[68:71], v25, s[32:35], s68 offen sc1
    buffer_store_dwordx4 v[96:99], v24, s[32:35], s69 offen sc1
    buffer_store_dwordx4 v[100:103], v25, s[32:35], s69 offen sc1
    s_nop 1
LFX_27:
    v_mov_b32 v4, 40
    v_mov_b32 v5, 1
    s_mov_b64 exec, 1
    ds_add_u32 v4, v5
    s_mov_b64 exec, -1
    s_branch L_F2
L_FMga:
    s_mov_b32 s56, 0xc000
    s_cmp_eq_u32 s50, 10
    s_cselect_b32 s56, 0xcfff, s56
    s_bitcmp1_b32 s56, s98
    s_cbranch_scc1 L_FMg2
    v_mov_b32 v4, 120
    v_mov_b32 v5, 1
    s_mov_b64 exec, 1
    ds_add_u32 v4, v5
    s_mov_b64 exec, -1
    s_branch L_F2
L_FMg2:
    v_mov_b32 v4, 36
    s_mov_b32 s65, 0
    s_nop 0
LW_28:
    ds_read_b32 v5, v4
    s_add_u32 s65, s65, 1
    s_cmp_gt_u32 s65, 4000000
    s_cbranch_scc1 L_end
    s_waitcnt lgkmcnt(0)
    v_readfirstlane_b32 s63, v5
    s_nop 0
    s_cmp_lt_u32 s63, 8
    s_nop 2
    s_cbranch_scc1 LW_28
    buffer_load_dwordx4 v[64:67], v7, s[36:39], s67 offen offset:0 nt
    s_add_u32 s62, s67, 12288
    buffer_load_dwordx4 v[68:71], v7, s[36:39], s62 offen nt
    s_add_u32 s62, s67, 24576
    buffer_load_dwordx4 v[72:75], v7, s[36:39], s62 offen nt
    s_add_u32 s62, s67, 36864
    buffer_load_dwordx4 v[76:79], v7, s[36:39], s62 offen nt
    s_add_u32 s62, s67, 49152
    buffer_load_dwordx4 v[80:83], v7, s[36:39], s62 offen nt
    s_add_u32 s62, s67, 61440
    buffer_load_dwordx4 v[84:87], v7, s[36:39], s62 offen nt
    s_add_u32 s62, s67, 73728
    buffer_load_dwordx4 v[88:91], v7, s[36:39], s62 offen nt
    s_add_u32 s62, s67, 86016
    buffer_load_dwordx4 v[92:95], v7, s[36:39], s62 offen nt
    buffer_load_dwordx4 v[96:99], v27, s[36:39], s67 offen offset:0 nt
    s_add_u32 s62, s67, 12288
    buffer_load_dwordx4 v[100:103], v27, s[36:39], s62 offen nt
    s_add_u32 s62, s67, 24576
    buffer_load_dwordx4 v[104:107], v27, s[36:39], s62 offen nt
    s_add_u32 s62, s67, 36864
    buffer_load_dwordx4 v[108:111], v27, s[36:39], s62 offen nt
    s_add_u32 s62, s67, 49152
    buffer_load_dwordx4 v[112:115], v27, s[36:39], s62 offen nt
    s_add_u32 s62, s67, 61440
    buffer_load_dwordx4 v[116:119], v27, s[36:39], s62 offen nt
    s_add_u32 s62, s67, 73728
    buffer_load_dwordx4 v[120:123], v27, s[36:39], s62 offen nt
    s_add_u32 s62, s67, 86016
    buffer_load_dwordx4 v[124:127], v27, s[36:39], s62 offen nt
    v_mov_b32 v4, 120
    v_mov_b32 v5, 1
    s_mov_b64 exec, 1
    ds_add_u32 v4, v5
    s_mov_b64 exec, -1
    s_waitcnt vmcnt(14)
    v_perm_b32 v32, v68, v64, s53
    v_perm_b32 v36, v68, v64, s54
    v_perm_b32 v40, v69, v65, s53
    v_perm_b32 v44, v69, v65, s54
    v_perm_b32 v48, v70, v66, s53
    v_perm_b32 v52, v70, v66, s54
    v_perm_b32 v56, v71, v67, s53
    v_perm_b32 v60, v71, v67, s54
    s_waitcnt vmcnt(12)
    v_perm_b32 v33, v76, v72, s53
    v_perm_b32 v37, v76, v72, s54
    v_perm_b32 v41, v77, v73, s53
    v_perm_b32 v45, v77, v73, s54
    v_perm_b32 v49, v78, v74, s53
    v_perm_b32 v53, v78, v74, s54
    v_perm_b32 v57, v79, v75, s53
    v_perm_b32 v61, v79, v75, s54
    s_waitcnt vmcnt(10)
    v_perm_b32 v34, v84, v80, s53
    v_perm_b32 v38, v84, v80, s54
    v_perm_b32 v42, v85, v81, s53
    v_perm_b32 v46, v85, v81, s54
    v_perm_b32 v50, v86, v82, s53
    v_perm_b32 v54, v86, v82, s54
    v_perm_b32 v58, v87, v83, s53
    v_perm_b32 v62, v87, v83, s54
    s_waitcnt vmcnt(8)
    v_perm_b32 v35, v92, v88, s53
    v_perm_b32 v39, v92, v88, s54
    v_perm_b32 v43, v93, v89, s53
    v_perm_b32 v47, v93, v89, s54
    v_perm_b32 v51, v94, v90, s53
    v_perm_b32 v55, v94, v90, s54
    v_perm_b32 v59, v95, v91, s53
    v_perm_b32 v63, v95, v91, s54
    v_mfma_f32_16x16x32_bf16 v[64:67], v[28:31], v[32:35], 0
    v_mfma_f32_16x16x32_bf16 v[68:71], v[28:31], v[36:39], 0
    v_mfma_f32_16x16x32_bf16 v[72:75], v[28:31], v[40:43], 0
    v_mfma_f32_16x16x32_bf16 v[76:79], v[28:31], v[44:47], 0
    v_mfma_f32_16x16x32_bf16 v[80:83], v[28:31], v[48:51], 0
    v_mfma_f32_16x16x32_bf16 v[84:87], v[28:31], v[52:55], 0
    v_mfma_f32_16x16x32_bf16 v[88:91], v[28:31], v[56:59], 0
    v_mfma_f32_16x16x32_bf16 v[92:95], v[28:31], v[60:63], 0
    s_nop 4
    v_permlane32_swap_b32 v64, v80
    v_permlane32_swap_b32 v65, v81
    v_permlane32_swap_b32 v66, v82
    v_permlane32_swap_b32 v67, v83
    v_permlane32_swap_b32 v68, v84
    v_permlane32_swap_b32 v69, v85
    v_permlane32_swap_b32 v70, v86
    v_permlane32_swap_b32 v71, v87
    v_permlane32_swap_b32 v72, v88
    v_permlane32_swap_b32 v73, v89
    v_permlane32_swap_b32 v74, v90
    v_permlane32_swap_b32 v75, v91
    v_permlane32_swap_b32 v76, v92
    v_permlane32_swap_b32 v77, v93
    v_permlane32_swap_b32 v78, v94
    v_permlane32_swap_b32 v79, v95
    v_add_f32_dpp v64, v80, v64 row_ror:8 row_mask:0xf bank_mask:0xf
    v_add_f32_dpp v65, v81, v65 row_ror:8 row_mask:0xf bank_mask:0xf
    v_add_f32_dpp v66, v82, v66 row_ror:8 row_mask:0xf bank_mask:0xf
    v_add_f32_dpp v67, v83, v67 row_ror:8 row_mask:0xf bank_mask:0xf
    v_add_f32_dpp v68, v84, v68 row_ror:8 row_mask:0xf bank_mask:0xf
    v_add_f32_dpp v69, v85, v69 row_ror:8 row_mask:0xf bank_mask:0xf
    v_add_f32_dpp v70, v86, v70 row_ror:8 row_mask:0xf bank_mask:0xf
    v_add_f32_dpp v71, v87, v71 row_ror:8 row_mask:0xf bank_mask:0xf
    v_add_f32_dpp v72, v88, v72 row_ror:8 row_mask:0xf bank_mask:0xf
    v_add_f32_dpp v73, v89, v73 row_ror:8 row_mask:0xf bank_mask:0xf
    v_add_f32_dpp v74, v90, v74 row_ror:8 row_mask:0xf bank_mask:0xf
    v_add_f32_dpp v75, v91, v75 row_ror:8 row_mask:0xf bank_mask:0xf
    v_add_f32_dpp v76, v92, v76 row_ror:8 row_mask:0xf bank_mask:0xf
    v_add_f32_dpp v77, v93, v77 row_ror:8 row_mask:0xf bank_mask:0xf
    v_add_f32_dpp v78, v94, v78 row_ror:8 row_mask:0xf bank_mask:0xf
    v_add_f32_dpp v79, v95, v79 row_ror:8 row_mask:0xf bank_mask:0xf
    v_mov_b32_dpp v64, v72 row_ror:8 row_mask:0xf bank_mask:0xc
    v_mov_b32_dpp v65, v73 row_ror:8 row_mask:0xf bank_mask:0xc
    v_mov_b32_dpp v66, v74 row_ror:8 row_mask:0xf bank_mask:0xc
    v_mov_b32_dpp v67, v75 row_ror:8 row_mask:0xf bank_mask:0xc
    v_mov_b32_dpp v68, v76 row_ror:8 row_mask:0xf bank_mask:0xc
    v_mov_b32_dpp v69, v77 row_ror:8 row_mask:0xf bank_mask:0xc
    v_mov_b32_dpp v70, v78 row_ror:8 row_mask:0xf bank_mask:0xc
    v_mov_b32_dpp v71, v79 row_ror:8 row_mask:0xf bank_mask:0xc
    v_bfi_b32 v64, s52, v3, v64
    v_bfi_b32 v65, s52, v3, v65
    v_bfi_b32 v66, s52, v3, v66
    v_bfi_b32 v67, s52, v3, v67
    v_bfi_b32 v68, s52, v3, v68
    v_bfi_b32 v69, s52, v3, v69
    v_bfi_b32 v70, s52, v3, v70
    v_bfi_b32 v71, s52, v3, v71
    s_waitcnt vmcnt(6)
    v_perm_b32 v32, v100, v96, s53
    v_perm_b32 v36, v100, v96, s54
    v_perm_b32 v40, v101, v97, s53
    v_perm_b32 v44, v101, v97, s54
    v_perm_b32 v48, v102, v98, s53
    v_perm_b32 v52, v102, v98, s54
    v_perm_b32 v56, v103, v99, s53
    v_perm_b32 v60, v103, v99, s54
    s_waitcnt vmcnt(4)
    v_perm_b32 v33, v108, v104, s53
    v_perm_b32 v37, v108, v104, s54
    v_perm_b32 v41, v109, v105, s53
    v_perm_b32 v45, v109, v105, s54
    v_perm_b32 v49, v110, v106, s53
    v_perm_b32 v53, v110, v106, s54
    v_perm_b32 v57, v111, v107, s53
    v_perm_b32 v61, v111, v107, s54
    s_waitcnt vmcnt(2)
    v_perm_b32 v34, v116, v112, s53
    v_perm_b32 v38, v116, v112, s54
    v_perm_b32 v42, v117, v113, s53
    v_perm_b32 v46, v117, v113, s54
    v_perm_b32 v50, v118, v114, s53
    v_perm_b32 v54, v118, v114, s54
    v_perm_b32 v58, v119, v115, s53
    v_perm_b32 v62, v119, v115, s54
    s_waitcnt vmcnt(0)
    v_perm_b32 v35, v124, v120, s53
    v_perm_b32 v39, v124, v120, s54
    v_perm_b32 v43, v125, v121, s53
    v_perm_b32 v47, v125, v121, s54
    v_perm_b32 v51, v126, v122, s53
    v_perm_b32 v55, v126, v122, s54
    v_perm_b32 v59, v127, v123, s53
    v_perm_b32 v63, v127, v123, s54
    buffer_store_dwordx4 v[64:67], v24, s[32:35], s68 offen
    buffer_store_dwordx4 v[68:71], v25, s[32:35], s68 offen
    v_mfma_f32_16x16x32_bf16 v[96:99], v[28:31], v[32:35], 0
    v_mfma_f32_16x16x32_bf16 v[100:103], v[28:31], v[36:39], 0
    v_mfma_f32_16x16x32_bf16 v[104:107], v[28:31], v[40:43], 0
    v_mfma_f32_16x16x32_bf16 v[108:111], v[28:31], v[44:47], 0
    v_mfma_f32_16x16x32_bf16 v[112:115], v[28:31], v[48:51], 0
    v_mfma_f32_16x16x32_bf16 v[116:119], v[28:31], v[52:55], 0
    v_mfma_f32_16x16x32_bf16 v[120:123], v[28:31], v[56:59], 0
    v_mfma_f32_16x16x32_bf16 v[124:127], v[28:31], v[60:63], 0
    s_nop 4
    v_permlane32_swap_b32 v96, v112
    v_permlane32_swap_b32 v97, v113
    v_permlane32_swap_b32 v98, v114
    v_permlane32_swap_b32 v99, v115
    v_permlane32_swap_b32 v100, v116
    v_permlane32_swap_b32 v101, v117
    v_permlane32_swap_b32 v102, v118
    v_permlane32_swap_b32 v103, v119
    v_permlane32_swap_b32 v104, v120
    v_permlane32_swap_b32 v105, v121
    v_permlane32_swap_b32 v106, v122
    v_permlane32_swap_b32 v107, v123
    v_permlane32_swap_b32 v108, v124
    v_permlane32_swap_b32 v109, v125
    v_permlane32_swap_b32 v110, v126
    v_permlane32_swap_b32 v111, v127
    v_add_f32_dpp v96, v112, v96 row_ror:8 row_mask:0xf bank_mask:0xf
    v_add_f32_dpp v97, v113, v97 row_ror:8 row_mask:0xf bank_mask:0xf
    v_add_f32_dpp v98, v114, v98 row_ror:8 row_mask:0xf bank_mask:0xf
    v_add_f32_dpp v99, v115, v99 row_ror:8 row_mask:0xf bank_mask:0xf
    v_add_f32_dpp v100, v116, v100 row_ror:8 row_mask:0xf bank_mask:0xf
    v_add_f32_dpp v101, v117, v101 row_ror:8 row_mask:0xf bank_mask:0xf
    v_add_f32_dpp v102, v118, v102 row_ror:8 row_mask:0xf bank_mask:0xf
    v_add_f32_dpp v103, v119, v103 row_ror:8 row_mask:0xf bank_mask:0xf
    v_add_f32_dpp v104, v120, v104 row_ror:8 row_mask:0xf bank_mask:0xf
    v_add_f32_dpp v105, v121, v105 row_ror:8 row_mask:0xf bank_mask:0xf
    v_add_f32_dpp v106, v122, v106 row_ror:8 row_mask:0xf bank_mask:0xf
    v_add_f32_dpp v107, v123, v107 row_ror:8 row_mask:0xf bank_mask:0xf
    v_add_f32_dpp v108, v124, v108 row_ror:8 row_mask:0xf bank_mask:0xf
    v_add_f32_dpp v109, v125, v109 row_ror:8 row_mask:0xf bank_mask:0xf
    v_add_f32_dpp v110, v126, v110 row_ror:8 row_mask:0xf bank_mask:0xf
    v_add_f32_dpp v111, v127, v111 row_ror:8 row_mask:0xf bank_mask:0xf
    v_mov_b32_dpp v96, v104 row_ror:8 row_mask:0xf bank_mask:0xc
    v_mov_b32_dpp v97, v105 row_ror:8 row_mask:0xf bank_mask:0xc
    v_mov_b32_dpp v98, v106 row_ror:8 row_mask:0xf bank_mask:0xc
    v_mov_b32_dpp v99, v107 row_ror:8 row_mask:0xf bank_mask:0xc
    v_mov_b32_dpp v100, v108 row_ror:8 row_mask:0xf bank_mask:0xc
    v_mov_b32_dpp v101, v109 row_ror:8 row_mask:0xf bank_mask:0xc
    v_mov_b32_dpp v102, v110 row_ror:8 row_mask:0xf bank_mask:0xc
    v_mov_b32_dpp v103, v111 row_ror:8 row_mask:0xf bank_mask:0xc
    v_bfi_b32 v96, s52, v3, v96
    v_bfi_b32 v97, s52, v3, v97
    v_bfi_b32 v98, s52, v3, v98
    v_bfi_b32 v99, s52, v3, v99
    v_bfi_b32 v100, s52, v3, v100
    v_bfi_b32 v101, s52, v3, v101
    v_bfi_b32 v102, s52, v3, v102
    v_bfi_b32 v103, s52, v3, v103
    buffer_store_dwordx4 v[96:99], v24, s[32:35], s69 offen
    buffer_store_dwordx4 v[100:103], v25, s[32:35], s69 offen
    s_cmp_eq_u32 s3, 1
    s_nop 0
    s_cbranch_scc1 LFX_29
    buffer_store_dwordx4 v[64:67], v24, s[32:35], s68 offen sc1
    buffer_store_dwordx4 v[68:71], v25, s[32:35], s68 offen sc1
    buffer_store_dwordx4 v[96:99], v24, s[32:35], s69 offen sc1
    buffer_store_dwordx4 v[100:103], v25, s[32:35], s69 offen sc1
    s_nop 1
LFX_29:
    v_mov_b32 v4, 56
    v_mov_b32 v5, 1
    s_mov_b64 exec, 1
    ds_add_u32 v4, v5
    s_mov_b64 exec, -1
    s_branch L_F2
L_FW:
    s_cmp_eq_u32 s50, 12
    s_cbranch_scc1 L_FW12
    s_waitcnt lgkmcnt(0)
    s_add_u32 s51, s64, 1
    s_and_b32 s51, s51, 0xff
    s_or_b32 s51, s51, 0xf00
    v_mov_b32 v3, s51
    s_getreg_b32 s61, hwreg(HW_REG_XCC_ID, 0, 4)
    s_add_u32 s56, s64, 1
    s_lshl_b32 s56, s56, 4
    s_or_b32 s61, s61, s56
    s_lshl_b32 s56, s48, 8
    s_lshl_b32 s57, s49, 2
    s_add_u32 s57, s57, s56
    s_add_u32 s57, s57, 16384
    v_mov_b32 v4, s61
    v_mov_b32 v5, 0
    s_mov_b64 exec, 1
    buffer_store_dword v4, v5, s[32:35], s57 offen
    s_mov_b64 exec, -1
    s_and_b32 s56, s98, 7
    s_cmp_lg_u32 s56, 2
    s_cbranch_scc1 L_FW13b
    s_xor_b32 s99, s98, 1
    s_lshl_b32 s99, s99, 1
    s_add_u32 s99, s99, s50
    s_sub_u32 s99, s99, 12
    s_branch L_HR
L_FW13b:
    s_lshl_b32 s56, s48, 8
    s_add_u32 s56, s56, 16384
    v_and_b32 v6, 31, v0
    v_lshlrev_b32 v6, 2, v6
    s_mov_b32 s65, 0
    s_mov_b32 s3, 1
LX_30:
    buffer_load_dword v7, v6, s[32:35], s56 offen sc1
    s_add_u32 s65, s65, 1
    s_waitcnt vmcnt(0)
    v_cmp_ne_u32 vcc, s61, v7
    s_nop 4
    s_cbranch_vccz LXD_31
    s_cmp_lt_u32 s65, 48
    s_cbranch_scc1 LX_30
    s_mov_b32 s3, 2
LXD_31:
    v_mov_b32 v4, 96
    v_mov_b32 v5, s3
    s_mov_b64 exec, 1
    ds_write_b32 v4, v5
    s_mov_b64 exec, -1
    s_branch L_F2
L_FW12:
    s_and_b32 s56, s98, 7
    s_cmp_lg_u32 s56, 2
    s_cbranch_scc1 L_FW12b
    s_xor_b32 s99, s98, 1
    s_lshl_b32 s99, s99, 1
    s_add_u32 s99, s99, s50
    s_sub_u32 s99, s99, 12
    s_branch L_HR
L_FW12b:
    s_waitcnt lgkmcnt(0)
    s_add_u32 s51, s64, 1
    s_and_b32 s51, s51, 0xff
    s_or_b32 s51, s51, 0xf00
    v_mov_b32 v3, s51
    s_nop 1
    s_branch L_F2
L_FR:
    s_mov_b32 s32, s30
    s_mov_b32 s33, s31
    s_mov_b32 s34, 268435456
    s_mov_b32 s35, 0x20000
    s_lshl_b32 s99, s98, 1
    s_add_u32 s99, s99, s50
    s_sub_u32 s99, s99, 14
L_HR:
    s_mov_b32 s36, s4
    s_mov_b32 s37, s5
    s_mov_b32 s38, 16384
    s_mov_b32 s39, 0x20000
    v_lshlrev_b32 v22, 11, v2
    v_and_b32 v4, 7, v0
    v_lshl_add_u32 v22, v4, 4, v22
    s_and_b32 s67, s99, 1
    s_lshl_b32 s67, s67, 13
    s_lshl_b32 s57, s48, 8
    s_add_u32 s67, s67, s57
    s_lshr_b32 s57, s99, 4
    s_lshl_b32 s57, s57, 7
    s_add_u32 s67, s67, s57
    s_and_b32 s57, s99, 14
    s_add_u32 s67, s67, s57
    buffer_load_ushort v23, v22, s[36:39], s67 offen
    v_bfe_u32 v4, v0, 2, 1
    v_lshlrev_b32 v26, 6, v4
    v_lshl_add_u32 v26, v2, 4, v26
    s_lshl_b32 s60, s48, 5
    s_add_u32 s60, s60, s99
    s_lshl_b32 s60, s60, 7
    s_lshl_b32 s59, s48, 17
    s_lshl_b32 s57, s99, 12
    s_add_u32 s59, s59, 3145728
    s_add_u32 s59, s59, s57
    v_lshlrev_b32 v29, 4, v0
    s_add_u32 s58, s60, 98304
    s_add_u32 s60, s60, 196608
    s_lshl_b32 s68, s48, 17
    s_lshl_b32 s57, s99, 12
    s_add_u32 s68, s68, s57
    s_and_b32 s57, s99, 1
    s_lshl_b32 s57, s57, 5
    v_lshlrev_b32 v25, 3, v2
    v_add_u32 v25, s57, v25
    s_and_b32 s56, s98, 7
    s_cmp_lg_u32 s56, 3
    s_cbranch_scc1 L_HR1
    s_waitcnt lgkmcnt(0)
    s_add_u32 s51, s64, 1
    s_and_b32 s51, s51, 0xff
    s_or_b32 s51, s51, 0xf00
    v_mov_b32 v3, s51
    s_waitcnt vmcnt(0)
    v_lshlrev_b32 v23, 16, v23
    s_nop 1
    s_branch L_HR2
L_HR1:
    buffer_load_dwordx4 v[32:35], v29, s[32:35], s59 offen sc1
    buffer_load_dwordx4 v[36:39], v29, s[32:35], s59 offen offset:1024 sc1
    buffer_load_dwordx4 v[40:43], v29, s[32:35], s59 offen offset:2048 sc1
    buffer_load_dwordx4 v[44:47], v29, s[32:35], s59 offen offset:3072 sc1
    s_waitcnt lgkmcnt(0)
    s_add_u32 s51, s64, 1
    s_and_b32 s51, s51, 0xff
    s_or_b32 s51, s51, 0xf00
    v_mov_b32 v3, s51
    v_mov_b32 v4, 0
    s_mov_b32 s65, 0
    s_nop 0
LW_32:
    ds_read_b32 v5, v4
    s_add_u32 s65, s65, 1
    s_cmp_gt_u32 s65, 4000000
    s_cbranch_scc1 L_end
    s_waitcnt lgkmcnt(0)
    v_readfirstlane_b32 s63, v5
    s_nop 0
    s_cmp_lt_u32 s63, 4
    s_nop 2
    s_cbranch_scc1 LW_32
    ds_read_b64 v[30:31], v25 offset:256
    s_waitcnt vmcnt(4) lgkmcnt(0)
    v_lshlrev_b32 v23, 16, v23
    v_sub_f32 v24, v23, v30
    v_cvt_pk_bf16_f32 v24, v24, v24
    v_and_b32 v24, 0xffff0000, v24
    v_mul_f32 v24, v24, v31
    v_cvt_pk_bf16_f32 v24, v24, v24
    v_and_b32 v24, 0xffff0000, v24
    s_and_b32 s14, s51, 0xff
    s_mov_b32 s65, 0
LP_34:
    buffer_load_dwordx4 v[32:35], v29, s[32:35], s59 offen sc1 nt
    buffer_load_dwordx4 v[36:39], v29, s[32:35], s59 offen offset:1024 sc1 nt
    buffer_load_dwordx4 v[40:43], v29, s[32:35], s59 offen offset:2048 sc1 nt
    buffer_load_dwordx4 v[44:47], v29, s[32:35], s59 offen offset:3072 sc1 nt
    s_add_u32 s65, s65, 1
    s_waitcnt vmcnt(3)
    v_xor_b32 v32, s14, v32
    v_xor_b32 v33, s14, v33
    v_xor_b32 v34, s14, v34
    v_xor_b32 v35, s14, v35
    v_or3_b32 v4, v32, v33, v34
    v_or_b32 v4, v4, v35
    s_waitcnt vmcnt(2)
    v_xor_b32 v36, s14, v36
    v_xor_b32 v37, s14, v37
    v_xor_b32 v38, s14, v38
    v_xor_b32 v39, s14, v39
    v_or3_b32 v4, v4, v36, v37
    v_or3_b32 v4, v4, v38, v39
    s_waitcnt vmcnt(1)
    v_xor_b32 v40, s14, v40
    v_xor_b32 v41, s14, v41
    v_xor_b32 v42, s14, v42
    v_xor_b32 v43, s14, v43
    v_or3_b32 v4, v4, v40, v41
    v_or3_b32 v4, v4, v42, v43
    s_waitcnt vmcnt(0)
    v_xor_b32 v44, s14, v44
    v_xor_b32 v45, s14, v45
    v_xor_b32 v46, s14, v46
    v_xor_b32 v47, s14, v47
    v_or3_b32 v4, v4, v44, v45
    v_or3_b32 v4, v4, v46, v47
    v_and_b32 v4, 0xff, v4
    v_cmp_ne_u32 vcc, 0, v4
    s_nop 4
    s_cbranch_vccz LD_33
    s_wqm_b64 exec, vcc
    s_cmp_lt_u32 s65, 200000
    s_cbranch_scc1 LP_34
    s_branch L_end
LD_33:
    s_mov_b64 exec, -1
    v_add_f32 v32, v32, v36
    v_add_f32 v40, v40, v44
    v_add_f32 v33, v33, v37
    v_add_f32 v41, v41, v45
    v_add_f32 v34, v34, v38
    v_add_f32 v42, v42, v46
    v_add_f32 v35, v35, v39
    v_add_f32 v43, v43, v47
    v_add_f32_dpp v32, v32, v32 row_ror:8 row_mask:0xf bank_mask:0xf
    v_add_f32_dpp v40, v40, v40 row_ror:8 row_mask:0xf bank_mask:0xf
    v_add_f32_dpp v33, v33, v33 row_ror:8 row_mask:0xf bank_mask:0xf
    v_add_f32_dpp v41, v41, v41 row_ror:8 row_mask:0xf bank_mask:0xf
    v_add_f32_dpp v34, v34, v34 row_ror:8 row_mask:0xf bank_mask:0xf
    v_add_f32_dpp v42, v42, v42 row_ror:8 row_mask:0xf bank_mask:0xf
    v_add_f32_dpp v35, v35, v35 row_ror:8 row_mask:0xf bank_mask:0xf
    v_add_f32_dpp v43, v43, v43 row_ror:8 row_mask:0xf bank_mask:0xf
    v_permlane32_swap_b32 v32, v40
    v_permlane32_swap_b32 v33, v41
    v_permlane32_swap_b32 v34, v42
    v_permlane32_swap_b32 v35, v43
    v_add_f32 v32, v32, v40
    v_add_f32 v33, v33, v41
    v_add_f32 v34, v34, v42
    v_add_f32 v35, v35, v43
    v_permlane16_swap_b32 v32, v33
    s_nop 0
    v_permlane16_swap_b32 v34, v35
    v_add_f32 v32, v32, v33
    v_add_f32 v34, v34, v35
    s_nop 1
    v_permlane32_swap_b32 v32, v34
    v_cvt_pk_bf16_f32 v4, v32, v34
    v_lshlrev_b32 v32, 16, v4
    v_and_b32 v34, 0xffff0000, v4
    v_add_f32 v34, 1.0, v34
    v_cvt_pk_bf16_f32 v34, v34, v34
    v_and_b32 v34, 0xffff0000, v34
    v_mul_f32 v24, v24, v34
    v_cvt_pk_bf16_f32 v24, v24, v24
    v_and_b32 v24, 0xffff0000, v24
    v_add_f32 v24, v24, v32
    v_cvt_pk_bf16_f32 v24, v24, v24
    v_and_or_b32 v24, v24, s55, v3
    s_nop 1
    v_mov_b32_dpp v8, v24 quad_perm:[0,0,0,0] row_mask:0xf bank_mask:0xf
    v_mov_b32_dpp v9, v24 quad_perm:[1,1,1,1] row_mask:0xf bank_mask:0xf
    v_mov_b32_dpp v10, v24 quad_perm:[2,2,2,2] row_mask:0xf bank_mask:0xf
    v_mov_b32_dpp v11, v24 quad_perm:[3,3,3,3] row_mask:0xf bank_mask:0xf
    s_mov_b32 exec_lo, 0x110011
    s_mov_b32 exec_hi, 0x110011
    buffer_store_dwordx4 v[8:11], v26, s[32:35], s58 offen sc1
    s_mov_b64 exec, -1
    s_nop 0
L_HR2:
    v_mov_b32 v4, 8
    v_mov_b32 v5, 1
    s_mov_b64 exec, 1
    ds_add_u32 v4, v5
    s_mov_b64 exec, -1
L_HR3:
    s_cmp_eq_u32 s50, 12
    s_cbranch_scc1 L_FW12b
    s_cmp_eq_u32 s50, 13
    s_cbranch_scc1 L_FW13b
    v_mov_b32 v4, 36
    s_mov_b32 s65, 0
    s_nop 0
LW_35:
    ds_read_b32 v5, v4
    s_add_u32 s65, s65, 1
    s_cmp_gt_u32 s65, 4000000
    s_cbranch_scc1 L_end
    s_waitcnt lgkmcnt(0)
    v_readfirstlane_b32 s63, v5
    s_nop 0
    s_cmp_lt_u32 s63, 8
    s_nop 2
    s_cbranch_scc1 LW_35
    s_lshl_b32 s59, s48, 17
    s_lshl_b32 s57, s99, 12
    s_add_u32 s59, s59, 5242880
    s_add_u32 s59, s59, s57
    v_lshlrev_b32 v6, 4, v0
    buffer_load_dwordx4 v[32:35], v6, s[32:35], s59 offen sc1
    buffer_load_dwordx4 v[36:39], v6, s[32:35], s59 offen offset:1024 sc1
    buffer_load_dwordx4 v[40:43], v6, s[32:35], s59 offen offset:2048 sc1
    buffer_load_dwordx4 v[44:47], v6, s[32:35], s59 offen offset:3072 sc1
    s_branch L_F2
L_EA:
    s_mov_b32 s32, s30
    s_mov_b32 s33, s31
    s_mov_b32 s34, 268435456
    s_mov_b32 s35, 0x20000
    s_mov_b32 s40, s6
    s_mov_b32 s41, s7
    s_mov_b32 s42, 33554432
    s_mov_b32 s43, 0x20000
    s_mov_b32 s44, s8
    s_mov_b32 s45, s9
    s_mov_b32 s46, 33554432
    s_mov_b32 s47, 0x20000
    s_sub_u32 s69, s50, 8
    s_lshl_b32 s67, s48, 2
    s_lshr_b32 s57, s98, 2
    s_add_u32 s67, s67, s57
    s_lshl_b32 s67, s67, 12
    s_and_b32 s57, s98, 3
    s_lshl_b32 s57, s57, 8
    s_add_u32 s67, s67, s57
    s_lshl_b32 s57, s69, 5
    s_add_u32 s67, s67, s57
    s_add_u32 s67, s67, 3072
    s_lshl_b32 s67, s67, 8
    s_add_u32 s68, s67, 4096
    v_and_b32 v24, 7, v1
    v_lshlrev_b32 v24, 8, v24
    v_lshrrev_b32 v4, 3, v1
    v_lshl_add_u32 v24, v4, 6, v24
    v_lshl_add_u32 v24, v2, 4, v24
    v_lshrrev_b32 v4, 1, v2
    v_lshlrev_b32 v25, 12, v4
    v_and_b32 v4, 1, v2
    v_lshl_add_u32 v25, v4, 10, v25
    v_lshl_add_u32 v25, v1, 4, v25
    s_waitcnt lgkmcnt(0)
    s_add_u32 s51, s64, 1
    s_and_b32 s51, s51, 0xff
    s_or_b32 s51, s51, 0xf00
    v_mov_b32 v3, s51
    buffer_load_dwordx4 v[32:35], v24, s[40:43], s67 offen offset:0 nt
    buffer_load_dwordx4 v[36:39], v24, s[40:43], s67 offen offset:128 nt
    buffer_load_dwordx4 v[40:43], v24, s[40:43], s67 offen offset:2048 nt
    buffer_load_dwordx4 v[44:47], v24, s[40:43], s67 offen offset:2176 nt
    v_mov_b32 v4, 4
    s_mov_b32 s65, 0
    s_nop 0
LW_36:
    ds_read_b32 v5, v4
    s_add_u32 s65, s65, 1
    s_cmp_gt_u32 s65, 4000000
    s_cbranch_scc1 L_end
    s_waitcnt lgkmcnt(0)
    v_readfirstlane_b32 s63, v5
    s_nop 0
    s_cmp_lt_u32 s63, 4
    s_nop 2
    s_cbranch_scc1 LW_36
    buffer_load_dwordx4 v[48:51], v24, s[40:43], s68 offen offset:0 nt
    buffer_load_dwordx4 v[52:55], v24, s[40:43], s68 offen offset:128 nt
    buffer_load_dwordx4 v[56:59], v24, s[40:43], s68 offen offset:2048 nt
    buffer_load_dwordx4 v[60:63], v24, s[40:43], s68 offen offset:2176 nt
    v_mov_b32 v4, 32
    v_mov_b32 v5, 1
    s_mov_b64 exec, 1
    ds_add_u32 v4, v5
    s_mov_b64 exec, -1
    v_mov_b32 v4, 32
    s_mov_b32 s65, 0
    s_nop 0
LW_37:
    ds_read_b32 v5, v4
    s_add_u32 s65, s65, 1
    s_cmp_gt_u32 s65, 4000000
    s_cbranch_scc1 L_end
    s_waitcnt lgkmcnt(0)
    v_readfirstlane_b32 s63, v5
    s_nop 0
    s_cmp_lt_u32 s63, 8
    s_nop 2
    s_cbranch_scc1 LW_37
    buffer_load_dwordx4 v[96:99], v25, s[44:47], s67 offen offset:0 nt
    buffer_load_dwordx4 v[100:103], v25, s[44:47], s67 offen offset:256 nt
    v_mov_b32 v4, 136
    v_mov_b32 v5, 1
    s_mov_b64 exec, 1
    ds_add_u32 v4, v5
    s_mov_b64 exec, -1
    buffer_load_dwordx4 v[104:107], v25, s[44:47], s67 offen offset:512 nt
    buffer_load_dwordx4 v[108:111], v25, s[44:47], s67 offen offset:768 nt
    buffer_load_dwordx4 v[112:115], v25, s[44:47], s67 offen offset:2048 nt
    buffer_load_dwordx4 v[116:119], v25, s[44:47], s67 offen offset:2304 nt
    buffer_load_dwordx4 v[120:123], v25, s[44:47], s67 offen offset:2560 nt
    buffer_load_dwordx4 v[124:127], v25, s[44:47], s67 offen offset:2816 nt
    v_mov_b32 v4, 132
    v_mov_b32 v5, 1
    s_mov_b64 exec, 1
    ds_add_u32 v4, v5
    s_mov_b64 exec, -1
    s_mul_i32 s56, s69, 4608
    v_lshrrev_b32 v4, 5, v0
    v_mul_u32_u24 v4, 1792, v4
    v_lshl_add_u32 v22, v0, 4, v4
    v_add_u32 v22, s56, v22
    s_lshl_b32 s57, s69, 2
    v_and_b32 v23, 7, v1
    v_lshlrev_b32 v21, 5, v23
    v_add_u32 v23, s57, v21
    v_lshrrev_b32 v4, 5, v0
    s_mov_b32 s56, 18432
    v_mul_lo_u32 v20, v4, s56
    v_and_b32 v5, 7, v0
    s_mov_b32 s56, 576
    v_mul_lo_u32 v5, v5, s56
    v_add_u32 v20, v20, v5
    v_bfe_u32 v5, v0, 3, 2
    v_lshl_add_u32 v20, v5, 4, v20
    s_lshl_b32 s56, s69, 6
    v_add_u32 v20, s56, v20
    v_and_b32 v5, 31, v0
    v_lshlrev_b32 v19, 4, v5
    s_lshl_b32 s59, s48, 2
    s_lshr_b32 s57, s98, 2
    s_add_u32 s59, s59, s57
    s_lshl_b32 s59, s59, 3
    s_add_u32 s59, s59, s69
    s_lshl_b32 s59, s59, 2
    s_and_b32 s57, s98, 3
    s_add_u32 s59, s59, s57
    s_lshl_b32 s59, s59, 9
    s_add_u32 s59, s59, 1048576
    s_mov_b32 s52, 0x1ff
    v_and_b32 v7, 7, v1
    v_lshl_add_u32 v7, v2, 4, v7
    v_lshlrev_b32 v7, 4, v7
    v_and_b32 v4, 1, v2
    v_lshl_add_u32 v7, v4, 7, v7
    v_lshrrev_b32 v4, 3, v1
    v_lshl_add_u32 v7, v4, 10, v7
    v_mov_b32 v4, 96
    s_mov_b32 s65, 0
    s_nop 0
LW_38:
    ds_read_b32 v5, v4
    s_add_u32 s65, s65, 1
    s_cmp_gt_u32 s65, 4000000
    s_cbranch_scc1 L_end
    s_waitcnt lgkmcnt(0)
    v_readfirstlane_b32 s63, v5
    s_nop 0
    s_cmp_lt_u32 s63, 1
    s_nop 2
    s_cbranch_scc1 LW_38
    s_mov_b32 s3, s63
    s_mov_b32 s6, 0x3db504f3
    s_mov_b32 s7, 0x3db504f3
    s_mov_b32 s8, 0x3fb8aa3b
    s_mov_b32 s9, 0x3fb8aa3b
    s_waitcnt vmcnt(6)
    v_perm_b32 v64, v100, v96, s53
    v_perm_b32 v68, v100, v96, s54
    v_perm_b32 v72, v101, v97, s53
    v_perm_b32 v76, v101, v97, s54
    v_perm_b32 v80, v102, v98, s53
    v_perm_b32 v84, v102, v98, s54
    v_perm_b32 v88, v103, v99, s53
    v_perm_b32 v92, v103, v99, s54
    s_waitcnt vmcnt(4)
    v_perm_b32 v65, v108, v104, s53
    v_perm_b32 v69, v108, v104, s54
    v_perm_b32 v73, v109, v105, s53
    v_perm_b32 v77, v109, v105, s54
    v_perm_b32 v81, v110, v106, s53
    v_perm_b32 v85, v110, v106, s54
    v_perm_b32 v89, v111, v107, s53
    v_perm_b32 v93, v111, v107, s54
    s_waitcnt vmcnt(2)
    v_perm_b32 v66, v116, v112, s53
    v_perm_b32 v70, v116, v112, s54
    v_perm_b32 v74, v117, v113, s53
    v_perm_b32 v78, v117, v113, s54
    v_perm_b32 v82, v118, v114, s53
    v_perm_b32 v86, v118, v114, s54
    v_perm_b32 v90, v119, v115, s53
    v_perm_b32 v94, v119, v115, s54
    s_waitcnt vmcnt(0)
    v_perm_b32 v67, v124, v120, s53
    v_perm_b32 v71, v124, v120, s54
    v_perm_b32 v75, v125, v121, s53
    v_perm_b32 v79, v125, v121, s54
    v_perm_b32 v83, v126, v122, s53
    v_perm_b32 v87, v126, v122, s54
    v_perm_b32 v91, v127, v123, s53
    v_perm_b32 v95, v127, v123, s54
    v_mov_b32 v120, 0
    v_mov_b32 v121, 0
    v_mov_b32 v122, 0
    v_mov_b32 v123, 0
    v_mov_b32 v124, 0
    v_mov_b32 v125, 0
    v_mov_b32 v126, 0
    v_mov_b32 v127, 0
    v_mov_b32 v4, 12
    s_mov_b32 s65, 0
    s_nop 0
LW_39:
    ds_read_b32 v5, v4
    s_add_u32 s65, s65, 1
    s_cmp_gt_u32 s65, 4000000
    s_cbranch_scc1 L_end
    s_waitcnt lgkmcnt(0)
    v_readfirstlane_b32 s63, v5
    s_nop 0
    s_cmp_lt_u32 s63, 4
    s_nop 2
    s_cbranch_scc1 LW_39
    ds_read_b128 v[96:99], v7 offset:2048
    ds_read_b128 v[100:103], v7 offset:4096
    s_waitcnt lgkmcnt(1)
    v_mfma_f32_16x16x32_bf16 v[24:27], v[32:35], v[96:99], 0
    v_mfma_f32_16x16x32_bf16 v[104:107], v[48:51], v[96:99], 0
    v_mfma_f32_16x16x32_bf16 v[28:31], v[40:43], v[96:99], 0
    v_mfma_f32_16x16x32_bf16 v[108:111], v[56:59], v[96:99], 0
    s_waitcnt lgkmcnt(0)
    v_mfma_f32_16x16x32_bf16 v[24:27], v[36:39], v[100:103], v[24:27]
    v_mfma_f32_16x16x32_bf16 v[104:107], v[52:55], v[100:103], v[104:107]
    v_mfma_f32_16x16x32_bf16 v[28:31], v[44:47], v[100:103], v[28:31]
    v_mfma_f32_16x16x32_bf16 v[108:111], v[60:63], v[100:103], v[108:111]
    s_nop 5
    v_permlane32_swap_b32 v24, v104
    v_permlane32_swap_b32 v25, v105
    v_permlane32_swap_b32 v26, v106
    v_permlane32_swap_b32 v27, v107
    v_permlane32_swap_b32 v28, v108
    v_permlane32_swap_b32 v29, v109
    v_permlane32_swap_b32 v30, v110
    v_permlane32_swap_b32 v31, v111
    v_add_f32_dpp v24, v104, v24 row_ror:8 row_mask:0xf bank_mask:0x3
    v_add_f32_dpp v25, v105, v25 row_ror:8 row_mask:0xf bank_mask:0x3
    v_add_f32_dpp v26, v106, v26 row_ror:8 row_mask:0xf bank_mask:0x3
    v_add_f32_dpp v27, v107, v27 row_ror:8 row_mask:0xf bank_mask:0x3
    v_add_f32_dpp v24, v28, v108 row_ror:8 row_mask:0xf bank_mask:0xc
    v_add_f32_dpp v25, v29, v109 row_ror:8 row_mask:0xf bank_mask:0xc
    v_add_f32_dpp v26, v30, v110 row_ror:8 row_mask:0xf bank_mask:0xc
    v_add_f32_dpp v27, v31, v111 row_ror:8 row_mask:0xf bank_mask:0xc
    v_cvt_pk_bf16_f32 v8, v24, v25
    v_cvt_pk_bf16_f32 v9, v26, v27
    v_lshlrev_b32 v24, 16, v8
    v_and_b32 v25, 0xffff0000, v8
    v_lshlrev_b32 v26, 16, v9
    v_and_b32 v27, 0xffff0000, v9
    v_pk_mul_f32 v[24:25], v[24:25], s[6:7]
    v_pk_mul_f32 v[26:27], v[26:27], s[6:7]
    v_cvt_pk_bf16_f32 v8, v24, v25
    v_cvt_pk_bf16_f32 v9, v26, v27
    v_lshlrev_b32 v24, 16, v8
    v_and_b32 v25, 0xffff0000, v8
    v_lshlrev_b32 v26, 16, v9
    v_and_b32 v27, 0xffff0000, v9
    v_max3_f32 v6, v24, v25, v26
    v_max_f32 v6, v6, v27
    s_nop 1
    v_max_f32_dpp v6, v6, v6 row_ror:8 row_mask:0xf bank_mask:0xf
    v_mov_b32 v5, v6
    s_nop 1
    v_permlane16_swap_b32 v6, v5
    v_max_f32 v6, v6, v5
    v_mov_b32 v5, v6
    s_nop 1
    v_permlane32_swap_b32 v6, v5
    v_max_f32 v6, v6, v5
    s_mov_b64 exec, 0xff
    ds_write_b32 v23, v6 offset:512
    s_mov_b64 exec, -1
    v_mov_b32 v4, 72
    v_mov_b32 v5, 1
    s_mov_b64 exec, 1
    ds_add_u32 v4, v5
    s_mov_b64 exec, -1
    v_mul_f32 v16, 0xbfb8aa3b, v6
    v_mul_f32 v17, 0xbfb8aa3b, v6
    v_pk_fma_f32 v[24:25], v[24:25], s[8:9], v[16:17]
    v_pk_fma_f32 v[26:27], v[26:27], s[8:9], v[16:17]
    v_exp_f32 v24, v24
    v_exp_f32 v25, v25
    v_exp_f32 v26, v26
    v_exp_f32 v27, v27
    v_mov_b32 v4, 72
    s_mov_b32 s65, 0
    s_nop 0
LW_40:
    ds_read_b32 v5, v4
    s_add_u32 s65, s65, 1
    s_cmp_gt_u32 s65, 4000000
    s_cbranch_scc1 L_end
    s_waitcnt lgkmcnt(0)
    v_readfirstlane_b32 s63, v5
    s_nop 0
    s_cmp_lt_u32 s63, 8
    s_nop 2
    s_cbranch_scc1 LW_40
    ds_read_b128 v[8:11], v21 offset:512
    ds_read_b128 v[12:15], v21 offset:528
    s_waitcnt lgkmcnt(0)
    v_max3_f32 v8, v8, v9, v10
    v_max3_f32 v11, v11, v12, v13
    v_max3_f32 v8, v8, v14, v15
    v_max_f32 v8, v8, v11
    v_sub_f32 v8, v6, v8
    v_mul_f32 v8, 0x3fb8aa3b, v8
    v_exp_f32 v8, v8
    s_nop 0
    v_mul_f32 v24, v24, v8
    v_mul_f32 v25, v25, v8
    v_mul_f32 v26, v26, v8
    v_mul_f32 v27, v27, v8
    v_cvt_pk_bf16_f32 v16, v24, v25
    v_cvt_pk_bf16_f32 v17, v26, v27
    s_nop 0
    v_mov_b32_dpp v120, v16 quad_perm:[0,1,2,3] row_mask:0xf bank_mask:0x3
    v_mov_b32_dpp v121, v17 quad_perm:[0,1,2,3] row_mask:0xf bank_mask:0x3
    v_mov_b32_dpp v122, v16 row_ror:8 row_mask:0xf bank_mask:0x3
    v_mov_b32_dpp v123, v17 row_ror:8 row_mask:0xf bank_mask:0x3
    s_nop 1
    v_mfma_f32_16x16x32_bf16 v[32:35], v[120:123], v[64:67], 0
    v_mov_b32_dpp v124, v16 row_ror:8 row_mask:0xf bank_mask:0xc
    v_mov_b32_dpp v125, v17 row_ror:8 row_mask:0xf bank_mask:0xc
    v_mov_b32_dpp v126, v16 quad_perm:[0,1,2,3] row_mask:0xf bank_mask:0xc
    v_mov_b32_dpp v127, v17 quad_perm:[0,1,2,3] row_mask:0xf bank_mask:0xc
    v_mfma_f32_16x16x32_bf16 v[36:39], v[120:123], v[68:71], 0
    v_mfma_f32_16x16x32_bf16 v[40:43], v[120:123], v[72:75], 0
    v_mfma_f32_16x16x32_bf16 v[44:47], v[120:123], v[76:79], 0
    v_mfma_f32_16x16x32_bf16 v[32:35], v[124:127], v[80:83], v[32:35]
    v_mfma_f32_16x16x32_bf16 v[36:39], v[124:127], v[84:87], v[36:39]
    v_mfma_f32_16x16x32_bf16 v[40:43], v[124:127], v[88:91], v[40:43]
    v_mfma_f32_16x16x32_bf16 v[44:47], v[124:127], v[92:95], v[44:47]
    v_pk_add_f32 v[24:25], v[24:25], v[26:27]
    v_add_f32 v7, v24, v25
    s_nop 1
    v_add_f32_dpp v7, v7, v7 row_ror:8 row_mask:0xf bank_mask:0xf
    v_mov_b32 v6, v7
    s_nop 1
    v_permlane16_swap_b32 v7, v6
    v_add_f32 v7, v7, v6
    v_mov_b32 v6, v7
    s_nop 1
    v_permlane32_swap_b32 v7, v6
    v_add_f32 v7, v7, v6
    s_mov_b64 exec, 0xff
    ds_write_b32 v23, v7 offset:768
    s_mov_b64 exec, -1
    v_mov_b32 v4, 76
    v_mov_b32 v5, 1
    s_mov_b64 exec, 1
    ds_add_u32 v4, v5
    s_mov_b64 exec, -1
    ds_write_b128 v22, v[32:35] offset:40960
    ds_write_b128 v22, v[36:39] offset:41536
    ds_write_b128 v22, v[40:43] offset:42112
    ds_write_b128 v22, v[44:47] offset:42688
    v_mov_b32 v4, 16
    v_mov_b32 v5, 1
    s_mov_b64 exec, 1
    ds_add_u32 v4, v5
    s_mov_b64 exec, -1
    v_mov_b32 v4, 16
    s_mov_b32 s65, 0
    s_nop 0
LW_41:
    ds_read_b32 v5, v4
    s_add_u32 s65, s65, 1
    s_cmp_gt_u32 s65, 4000000
    s_cbranch_scc1 L_end
    s_waitcnt lgkmcnt(0)
    v_readfirstlane_b32 s63, v5
    s_nop 0
    s_cmp_lt_u32 s63, 8
    s_nop 2
    s_cbranch_scc1 LW_41
    ds_read_b128 v[96:99], v20 offset:40960
    ds_read_b128 v[100:103], v20 offset:45568
    ds_read_b128 v[104:107], v20 offset:50176
    ds_read_b128 v[108:111], v20 offset:54784
    s_waitcnt lgkmcnt(2)
    v_pk_add_f32 v[96:97], v[96:97], v[100:101]
    v_pk_add_f32 v[98:99], v[98:99], v[102:103]
    s_waitcnt lgkmcnt(0)
    v_pk_add_f32 v[104:105], v[104:105], v[108:109]
    v_pk_add_f32 v[106:107], v[106:107], v[110:111]
    v_pk_add_f32 v[96:97], v[96:97], v[104:105]
    v_pk_add_f32 v[98:99], v[98:99], v[106:107]
    s_nop 1
    v_permlane32_swap_b32 v96, v98
    v_permlane32_swap_b32 v97, v99
    v_add_f32 v96, v96, v98
    v_add_f32 v97, v97, v99
    v_bfi_b32 v96, s52, v3, v96
    v_bfi_b32 v97, s52, v3, v97
    v_mov_b32 v98, v96
    v_mov_b32 v99, v97
    s_nop 0
    v_permlane32_swap_b32 v96, v98
    v_permlane32_swap_b32 v97, v99
    s_mov_b32 exec_hi, 0
    buffer_store_dwordx4 v[96:99], v19, s[32:35], s59 offen
    s_cmp_eq_u32 s3, 1
    s_nop 0
    s_cbranch_scc1 LFX_42
    buffer_store_dwordx4 v[96:99], v19, s[32:35], s59 offen sc1
    s_nop 1
LFX_42:
    s_mov_b32 exec_hi, -1
    s_cmp_eq_u32 s50, 15
    s_cbranch_scc1 L_GB
    s_sub_u32 s68, s50, 8
    s_mul_i32 s56, s68, 4352
    v_lshrrev_b32 v4, 5, v0
    v_mul_u32_u24 v4, 1664, v4
    v_lshl_add_u32 v22, v0, 4, v4
    v_add_u32 v22, s56, v22
    v_lshrrev_b32 v4, 5, v0
    v_mul_u32_u24 v23, 17408, v4
    v_and_b32 v4, 31, v0
    v_lshl_add_u32 v23, v4, 4, v23
    s_mul_i32 s56, s68, 544
    v_add_u32 v23, s56, v23
    v_lshrrev_b32 v4, 3, v1
    v_lshlrev_b32 v24, 16, v4
    v_and_b32 v4, 1, v2
    v_lshl_add_u32 v24, v4, 12, v24
    v_and_b32 v4, 7, v1
    v_lshl_add_u32 v24, v4, 4, v24
    s_lshl_b32 s69, s48, 17
    s_lshl_b32 s56, s68, 13
    s_add_u32 s69, s69, s56
    s_lshl_b32 s56, s98, 7
    s_add_u32 s69, s69, s56
    s_add_u32 s69, s69, 7340032
    s_mov_b32 s52, 0x1ff
    s_mov_b32 s36, s20
    s_mov_b32 s37, s21
    s_mov_b32 s38, 7340032
    s_mov_b32 s39, 0x20000
    v_lshlrev_b32 v7, 14, v2
    v_lshl_add_u32 v7, v1, 4, v7
    s_mul_i32 s56, s98, 7
    s_add_u32 s56, s56, s68
    s_lshl_b32 s60, s56, 16
    s_lshl_b32 s57, s48, 8
    s_add_u32 s60, s60, s57
    v_and_b32 v6, 7, v1
    v_lshlrev_b32 v6, 5, v6
    v_lshl_add_u32 v6, v2, 8, v6
    v_lshrrev_b32 v4, 3, v1
    v_lshl_add_u32 v6, v4, 4, v6
    s_lshr_b32 s59, s56, 1
    s_lshl_b32 s59, s59, 12
    s_and_b32 s57, s56, 1
    s_lshl_b32 s57, s57, 10
    s_add_u32 s59, s59, s57
    s_add_u32 s59, s59, 655360
    v_mov_b32 v120, 0
    v_mov_b32 v121, 0
    v_mov_b32 v122, 0
    v_mov_b32 v123, 0
    v_mov_b32 v124, 0
    v_mov_b32 v125, 0
    v_mov_b32 v126, 0
    v_mov_b32 v127, 0
    s_barrier
    v_mov_b32 v4, 52
    s_mov_b32 s65, 0
    s_nop 0
LW_43:
    ds_read_b32 v5, v4
    s_add_u32 s65, s65, 1
    s_cmp_gt_u32 s65, 4000000
    s_cbranch_scc1 L_end
    s_waitcnt lgkmcnt(0)
    v_readfirstlane_b32 s63, v5
    s_nop 0
    s_cmp_lt_u32 s63, 2
    s_nop 2
    s_cbranch_scc1 LW_43
    buffer_load_dwordx4 v[64:67], v7, s[36:39], s60 offen offset:0 nt
    buffer_load_dwordx4 v[68:71], v7, s[36:39], s60 offen offset:2048 nt
    s_add_u32 s62, s60, 4096
    buffer_load_dwordx4 v[72:75], v7, s[36:39], s62 offen nt
    s_add_u32 s62, s60, 6144
    buffer_load_dwordx4 v[76:79], v7, s[36:39], s62 offen nt
    s_add_u32 s62, s60, 8192
    buffer_load_dwordx4 v[80:83], v7, s[36:39], s62 offen nt
    s_add_u32 s62, s60, 10240
    buffer_load_dwordx4 v[84:87], v7, s[36:39], s62 offen nt
    s_add_u32 s62, s60, 12288
    buffer_load_dwordx4 v[88:91], v7, s[36:39], s62 offen nt
    s_add_u32 s62, s60, 14336
    buffer_load_dwordx4 v[92:95], v7, s[36:39], s62 offen nt
    s_waitcnt vmcnt(6)
    v_perm_b32 v32, v68, v64, s53
    v_perm_b32 v36, v68, v64, s54
    v_perm_b32 v40, v69, v65, s53
    v_perm_b32 v44, v69, v65, s54
    v_perm_b32 v48, v70, v66, s53
    v_perm_b32 v52, v70, v66, s54
    v_perm_b32 v56, v71, v67, s53
    v_perm_b32 v60, v71, v67, s54
    s_waitcnt vmcnt(4)
    v_perm_b32 v33, v76, v72, s53
    v_perm_b32 v37, v76, v72, s54
    v_perm_b32 v41, v77, v73, s53
    v_perm_b32 v45, v77, v73, s54
    v_perm_b32 v49, v78, v74, s53
    v_perm_b32 v53, v78, v74, s54
    v_perm_b32 v57, v79, v75, s53
    v_perm_b32 v61, v79, v75, s54
    s_waitcnt vmcnt(2)
    v_perm_b32 v34, v84, v80, s53
    v_perm_b32 v38, v84, v80, s54
    v_perm_b32 v42, v85, v81, s53
    v_perm_b32 v46, v85, v81, s54
    v_perm_b32 v50, v86, v82, s53
    v_perm_b32 v54, v86, v82, s54
    v_perm_b32 v58, v87, v83, s53
    v_perm_b32 v62, v87, v83, s54
    s_waitcnt vmcnt(0)
    v_perm_b32 v35, v92, v88, s53
    v_perm_b32 v39, v92, v88, s54
    v_perm_b32 v43, v93, v89, s53
    v_perm_b32 v47, v93, v89, s54
    v_perm_b32 v51, v94, v90, s53
    v_perm_b32 v55, v94, v90, s54
    v_perm_b32 v59, v95, v91, s53
    v_perm_b32 v63, v95, v91, s54
    v_mov_b32 v4, 112
    s_mov_b32 s65, 0
    s_nop 0
LW_44:
    ds_read_b32 v5, v4
    s_add_u32 s65, s65, 1
    s_cmp_gt_u32 s65, 4000000
    s_cbranch_scc1 L_end
    s_waitcnt lgkmcnt(0)
    v_readfirstlane_b32 s63, v5
    s_nop 0
    s_cmp_lt_u32 s63, 1
    s_nop 2
    s_cbranch_scc1 LW_44
    s_mov_b32 s65, 0
LP_46:
    buffer_load_dwordx4 v[96:99], v6, s[32:35], s59 offen sc1
    buffer_load_dwordx4 v[104:107], v6, s[32:35], s59 offen offset:2048 sc1
    s_add_u32 s65, s65, 1
    s_waitcnt vmcnt(1)
    v_xor_b32 v96, v3, v96
    v_xor_b32 v97, v3, v97
    v_xor_b32 v98, v3, v98
    v_xor_b32 v99, v3, v99
    v_or3_b32 v4, v96, v97, v98
    v_or_b32 v4, v4, v99
    s_waitcnt vmcnt(0)
    v_xor_b32 v104, v3, v104
    v_xor_b32 v105, v3, v105
    v_xor_b32 v106, v3, v106
    v_xor_b32 v107, v3, v107
    v_or3_b32 v4, v4, v104, v105
    v_or3_b32 v4, v4, v106, v107
    v_and_b32 v4, 0xffff, v4
    v_cmp_ne_u32 vcc, 0, v4
    s_nop 4
    s_cbranch_vccz LD_45
    s_mov_b64 exec, vcc
    s_cmp_lt_u32 s65, 200000
    s_cbranch_scc1 LP_46
    s_branch L_end
LD_45:
    s_mov_b64 exec, -1
    v_pk_mul_f32 v[96:97], v[96:97], v[104:105]
    v_pk_mul_f32 v[98:99], v[98:99], v[106:107]
    v_cvt_pk_bf16_f32 v16, v96, v97
    v_cvt_pk_bf16_f32 v17, v98, v99
    s_nop 0
    v_mov_b32_dpp v120, v16 quad_perm:[0,1,2,3] row_mask:0xf bank_mask:0x3
    v_mov_b32_dpp v121, v17 quad_perm:[0,1,2,3] row_mask:0xf bank_mask:0x3
    v_mov_b32_dpp v122, v16 row_ror:8 row_mask:0xf bank_mask:0x3
    v_mov_b32_dpp v123, v17 row_ror:8 row_mask:0xf bank_mask:0x3
    s_nop 1
    v_mfma_f32_16x16x32_bf16 v[64:67], v[120:123], v[32:35], 0
    v_mov_b32_dpp v124, v16 row_ror:8 row_mask:0xf bank_mask:0xc
    v_mov_b32_dpp v125, v17 row_ror:8 row_mask:0xf bank_mask:0xc
    v_mov_b32_dpp v126, v16 quad_perm:[0,1,2,3] row_mask:0xf bank_mask:0xc
    v_mov_b32_dpp v127, v17 quad_perm:[0,1,2,3] row_mask:0xf bank_mask:0xc
    v_mfma_f32_16x16x32_bf16 v[68:71], v[120:123], v[36:39], 0
    v_mfma_f32_16x16x32_bf16 v[72:75], v[120:123], v[40:43], 0
    v_mfma_f32_16x16x32_bf16 v[76:79], v[120:123], v[44:47], 0
    v_mfma_f32_16x16x32_bf16 v[64:67], v[124:127], v[48:51], v[64:67]
    v_mfma_f32_16x16x32_bf16 v[68:71], v[124:127], v[52:55], v[68:71]
    v_mfma_f32_16x16x32_bf16 v[72:75], v[124:127], v[56:59], v[72:75]
    v_mfma_f32_16x16x32_bf16 v[76:79], v[124:127], v[60:63], v[76:79]
    s_nop 4
    ds_write_b128 v22, v[64:67] offset:40960
    ds_write_b128 v22, v[68:71] offset:41504
    ds_write_b128 v22, v[72:75] offset:42048
    ds_write_b128 v22, v[76:79] offset:42592
L_WDf:
    s_waitcnt lgkmcnt(0)
    s_barrier
    ds_read_b128 v[32:35], v23 offset:40960
    ds_read_b128 v[36:39], v23 offset:45312
    ds_read_b128 v[40:43], v23 offset:49664
    ds_read_b128 v[44:47], v23 offset:54016
    s_waitcnt lgkmcnt(2)
    v_pk_add_f32 v[32:33], v[32:33], v[36:37]
    v_pk_add_f32 v[34:35], v[34:35], v[38:39]
    s_waitcnt lgkmcnt(0)
    v_pk_add_f32 v[40:41], v[40:41], v[44:45]
    v_pk_add_f32 v[42:43], v[42:43], v[46:47]
    v_pk_add_f32 v[32:33], v[32:33], v[40:41]
    v_pk_add_f32 v[34:35], v[34:35], v[42:43]
    s_nop 1
    v_permlane32_swap_b32 v32, v34
    v_permlane32_swap_b32 v33, v35
    v_add_f32 v32, v32, v34
    v_add_f32 v33, v33, v35
    v_bfi_b32 v32, s52, v3, v32
    v_bfi_b32 v33, s52, v3, v33
    v_mov_b32 v34, v32
    v_mov_b32 v35, v33
    s_nop 0
    v_permlane32_swap_b32 v32, v34
    v_permlane32_swap_b32 v33, v35
    s_mov_b32 exec_hi, 0
    buffer_store_dwordx4 v[32:35], v24, s[32:35], s69 offen
    s_cmp_eq_u32 s3, 1
    s_nop 0
    s_cbranch_scc1 LFX_47
    buffer_store_dwordx4 v[32:35], v24, s[32:35], s69 offen sc1
    s_nop 1
LFX_47:
    s_mov_b32 exec_hi, -1
    v_mov_b32 v4, 64
    v_mov_b32 v5, 1
    s_mov_b64 exec, 1
    ds_add_u32 v4, v5
    s_mov_b64 exec, -1
    s_branch L_fin
L_GB:
    s_mov_b32 s40, s22
    s_mov_b32 s41, s23
    s_mov_b32 s42, 16384
    s_mov_b32 s43, 0x20000
    v_lshrrev_b32 v5, 3, v1
    v_lshl_add_u32 v5, v5, 2, v2
    v_lshlrev_b32 v5, 4, v5
    v_and_b32 v6, 7, v1
    s_mov_b32 s62, 2048
    v_mul_lo_u32 v6, v6, s62
    v_add_u32 v6, v6, v5
    s_lshl_b32 s60, s98, 7
    buffer_load_dwordx4 v[8:11], v6, s[40:43], s60 offen
    s_mov_b32 s36, s24
    s_mov_b32 s37, s25
    s_mov_b32 s38, 12582912
    s_mov_b32 s39, 0x20000
    s_mov_b32 s57, 5
    s_mov_b32 s58, 1
    s_mul_i32 s67, s98, 786432
    s_lshl_b32 s60, s48, 8
    s_add_u32 s67, s67, s60
    s_lshl_b32 s60, s57, 11
    s_add_u32 s67, s67, s60
    s_lshl_b32 s68, s58, 20
    s_lshl_b32 s60, s48, 17
    s_add_u32 s68, s68, s60
    s_add_u32 s68, s68, 3145728
    s_lshl_b32 s60, s58, 11
    s_add_u32 s68, s68, s60
    s_lshl_b32 s60, s98, 7
    s_add_u32 s68, s68, s60
    s_add_u32 s69, s68, 0x10000
    v_lshrrev_b32 v5, 3, v1
    v_lshl_add_u32 v5, v5, 2, v2
    s_mov_b32 s62, 98304
    v_mul_lo_u32 v5, v5, s62
    v_and_b32 v7, 7, v1
    v_lshl_add_u32 v7, v7, 4, v5
    v_add_u32 v27, 128, v7
    s_mov_b32 s52, 0x1ff
    v_lshlrev_b32 v26, 4, v0
    v_lshrrev_b32 v4, 3, v1
    v_lshrrev_b32 v5, 1, v2
    v_lshl_add_u32 v4, v5, 1, v4
    v_and_b32 v5, 1, v2
    v_lshl_add_u32 v4, v4, 2, v5
    v_lshlrev_b32 v24, 12, v4
    v_and_b32 v4, 7, v1
    v_lshl_add_u32 v24, v4, 4, v24
    v_add_u32 v25, 0x2000, v24
    s_barrier
    s_waitcnt vmcnt(0)
    v_lshlrev_b32 v12, 16, v8
    v_and_b32 v13, 0xffff0000, v8
    v_lshlrev_b32 v14, 16, v9
    v_and_b32 v15, 0xffff0000, v9
    v_lshlrev_b32 v16, 16, v10
    v_and_b32 v17, 0xffff0000, v10
    v_lshlrev_b32 v18, 16, v11
    v_and_b32 v19, 0xffff0000, v11
    v_mul_f32 v4, 0xbfb8aa3b, v12
    v_exp_f32 v4, v4
    s_nop 0
    v_add_f32 v4, 1.0, v4
    v_rcp_f32 v4, v4
    s_nop 0
    v_mul_f32 v12, v12, v4
    v_mul_f32 v5, 0xbfb8aa3b, v13
    v_exp_f32 v5, v5
    s_nop 0
    v_add_f32 v5, 1.0, v5
    v_rcp_f32 v5, v5
    s_nop 0
    v_mul_f32 v13, v13, v5
    v_mul_f32 v4, 0xbfb8aa3b, v14
    v_exp_f32 v4, v4
    s_nop 0
    v_add_f32 v4, 1.0, v4
    v_rcp_f32 v4, v4
    s_nop 0
    v_mul_f32 v14, v14, v4
    v_mul_f32 v5, 0xbfb8aa3b, v15
    v_exp_f32 v5, v5
    s_nop 0
    v_add_f32 v5, 1.0, v5
    v_rcp_f32 v5, v5
    s_nop 0
    v_mul_f32 v15, v15, v5
    v_mul_f32 v4, 0xbfb8aa3b, v16
    v_exp_f32 v4, v4
    s_nop 0
    v_add_f32 v4, 1.0, v4
    v_rcp_f32 v4, v4
    s_nop 0
    v_mul_f32 v16, v16, v4
    v_mul_f32 v5, 0xbfb8aa3b, v17
    v_exp_f32 v5, v5
    s_nop 0
    v_add_f32 v5, 1.0, v5
    v_rcp_f32 v5, v5
    s_nop 0
    v_mul_f32 v17, v17, v5
    v_mul_f32 v4, 0xbfb8aa3b, v18
    v_exp_f32 v4, v4
    s_nop 0
    v_add_f32 v4, 1.0, v4
    v_rcp_f32 v4, v4
    s_nop 0
    v_mul_f32 v18, v18, v4
    v_mul_f32 v5, 0xbfb8aa3b, v19
    v_exp_f32 v5, v5
    s_nop 0
    v_add_f32 v5, 1.0, v5
    v_rcp_f32 v5, v5
    s_nop 0
    v_mul_f32 v19, v19, v5
    v_cvt_pk_bf16_f32 v28, v12, v13
    v_cvt_pk_bf16_f32 v29, v14, v15
    v_cvt_pk_bf16_f32 v30, v16, v17
    v_cvt_pk_bf16_f32 v31, v18, v19
    v_mov_b32 v12, 0
    v_mov_b32 v13, 0
    v_mov_b32 v14, 0
    v_mov_b32 v15, 0
    v_lshrrev_b32 v4, 5, v0
    v_lshl_add_u32 v4, v4, 5, v26
    v_add_u32 v4, 71424, v4
    ds_write_b128 v4, v[12:15] offset:0
    ds_write_b128 v4, v[12:15] offset:1088
    ds_write_b128 v4, v[12:15] offset:2176
    ds_write_b128 v4, v[12:15] offset:3264
    v_mov_b32 v4, 52
    s_mov_b32 s65, 0
    s_nop 0
LW_48:
    ds_read_b32 v5, v4
    s_add_u32 s65, s65, 1
    s_cmp_gt_u32 s65, 4000000
    s_cbranch_scc1 L_end
    s_waitcnt lgkmcnt(0)
    v_readfirstlane_b32 s63, v5
    s_nop 0
    s_cmp_lt_u32 s63, 2
    s_nop 2
    s_cbranch_scc1 LW_48
    buffer_load_dwordx4 v[64:67], v7, s[36:39], s67 offen offset:0 nt
    s_add_u32 s62, s67, 12288
    buffer_load_dwordx4 v[68:71], v7, s[36:39], s62 offen nt
    s_add_u32 s62, s67, 24576
    buffer_load_dwordx4 v[72:75], v7, s[36:39], s62 offen nt
    s_add_u32 s62, s67, 36864
    buffer_load_dwordx4 v[76:79], v7, s[36:39], s62 offen nt
    s_add_u32 s62, s67, 49152
    buffer_load_dwordx4 v[80:83], v7, s[36:39], s62 offen nt
    s_add_u32 s62, s67, 61440
    buffer_load_dwordx4 v[84:87], v7, s[36:39], s62 offen nt
    s_add_u32 s62, s67, 73728
    buffer_load_dwordx4 v[88:91], v7, s[36:39], s62 offen nt
    s_add_u32 s62, s67, 86016
    buffer_load_dwordx4 v[92:95], v7, s[36:39], s62 offen nt
    buffer_load_dwordx4 v[96:99], v27, s[36:39], s67 offen offset:0 nt
    s_add_u32 s62, s67, 12288
    buffer_load_dwordx4 v[100:103], v27, s[36:39], s62 offen nt
    s_add_u32 s62, s67, 24576
    buffer_load_dwordx4 v[104:107], v27, s[36:39], s62 offen nt
    s_add_u32 s62, s67, 36864
    buffer_load_dwordx4 v[108:111], v27, s[36:39], s62 offen nt
    s_add_u32 s62, s67, 49152
    buffer_load_dwordx4 v[112:115], v27, s[36:39], s62 offen nt
    s_add_u32 s62, s67, 61440
    buffer_load_dwordx4 v[116:119], v27, s[36:39], s62 offen nt
    s_add_u32 s62, s67, 73728
    buffer_load_dwordx4 v[120:123], v27, s[36:39], s62 offen nt
    s_add_u32 s62, s67, 86016
    buffer_load_dwordx4 v[124:127], v27, s[36:39], s62 offen nt
    v_mov_b32 v4, 124
    v_mov_b32 v5, 1
    s_mov_b64 exec, 1
    ds_add_u32 v4, v5
    s_mov_b64 exec, -1
    s_waitcnt vmcnt(14)
    v_perm_b32 v32, v68, v64, s53
    v_perm_b32 v36, v68, v64, s54
    v_perm_b32 v40, v69, v65, s53
    v_perm_b32 v44, v69, v65, s54
    v_perm_b32 v48, v70, v66, s53
    v_perm_b32 v52, v70, v66, s54
    v_perm_b32 v56, v71, v67, s53
    v_perm_b32 v60, v71, v67, s54
    s_waitcnt vmcnt(12)
    v_perm_b32 v33, v76, v72, s53
    v_perm_b32 v37, v76, v72, s54
    v_perm_b32 v41, v77, v73, s53
    v_perm_b32 v45, v77, v73, s54
    v_perm_b32 v49, v78, v74, s53
    v_perm_b32 v53, v78, v74, s54
    v_perm_b32 v57, v79, v75, s53
    v_perm_b32 v61, v79, v75, s54
    s_waitcnt vmcnt(10)
    v_perm_b32 v34, v84, v80, s53
    v_perm_b32 v38, v84, v80, s54
    v_perm_b32 v42, v85, v81, s53
    v_perm_b32 v46, v85, v81, s54
    v_perm_b32 v50, v86, v82, s53
    v_perm_b32 v54, v86, v82, s54
    v_perm_b32 v58, v87, v83, s53
    v_perm_b32 v62, v87, v83, s54
    s_waitcnt vmcnt(8)
    v_perm_b32 v35, v92, v88, s53
    v_perm_b32 v39, v92, v88, s54
    v_perm_b32 v43, v93, v89, s53
    v_perm_b32 v47, v93, v89, s54
    v_perm_b32 v51, v94, v90, s53
    v_perm_b32 v55, v94, v90, s54
    v_perm_b32 v59, v95, v91, s53
    v_perm_b32 v63, v95, v91, s54
    v_mfma_f32_16x16x32_bf16 v[64:67], v[28:31], v[32:35], 0
    v_mfma_f32_16x16x32_bf16 v[68:71], v[28:31], v[36:39], 0
    v_mfma_f32_16x16x32_bf16 v[72:75], v[28:31], v[40:43], 0
    v_mfma_f32_16x16x32_bf16 v[76:79], v[28:31], v[44:47], 0
    v_mfma_f32_16x16x32_bf16 v[80:83], v[28:31], v[48:51], 0
    v_mfma_f32_16x16x32_bf16 v[84:87], v[28:31], v[52:55], 0
    v_mfma_f32_16x16x32_bf16 v[88:91], v[28:31], v[56:59], 0
    v_mfma_f32_16x16x32_bf16 v[92:95], v[28:31], v[60:63], 0
    s_nop 4
    v_permlane32_swap_b32 v64, v80
    v_permlane32_swap_b32 v65, v81
    v_permlane32_swap_b32 v66, v82
    v_permlane32_swap_b32 v67, v83
    v_permlane32_swap_b32 v68, v84
    v_permlane32_swap_b32 v69, v85
    v_permlane32_swap_b32 v70, v86
    v_permlane32_swap_b32 v71, v87
    v_permlane32_swap_b32 v72, v88
    v_permlane32_swap_b32 v73, v89
    v_permlane32_swap_b32 v74, v90
    v_permlane32_swap_b32 v75, v91
    v_permlane32_swap_b32 v76, v92
    v_permlane32_swap_b32 v77, v93
    v_permlane32_swap_b32 v78, v94
    v_permlane32_swap_b32 v79, v95
    v_add_f32_dpp v64, v80, v64 row_ror:8 row_mask:0xf bank_mask:0xf
    v_add_f32_dpp v65, v81, v65 row_ror:8 row_mask:0xf bank_mask:0xf
    v_add_f32_dpp v66, v82, v66 row_ror:8 row_mask:0xf bank_mask:0xf
    v_add_f32_dpp v67, v83, v67 row_ror:8 row_mask:0xf bank_mask:0xf
    v_add_f32_dpp v68, v84, v68 row_ror:8 row_mask:0xf bank_mask:0xf
    v_add_f32_dpp v69, v85, v69 row_ror:8 row_mask:0xf bank_mask:0xf
    v_add_f32_dpp v70, v86, v70 row_ror:8 row_mask:0xf bank_mask:0xf
    v_add_f32_dpp v71, v87, v71 row_ror:8 row_mask:0xf bank_mask:0xf
    v_add_f32_dpp v72, v88, v72 row_ror:8 row_mask:0xf bank_mask:0xf
    v_add_f32_dpp v73, v89, v73 row_ror:8 row_mask:0xf bank_mask:0xf
    v_add_f32_dpp v74, v90, v74 row_ror:8 row_mask:0xf bank_mask:0xf
    v_add_f32_dpp v75, v91, v75 row_ror:8 row_mask:0xf bank_mask:0xf
    v_add_f32_dpp v76, v92, v76 row_ror:8 row_mask:0xf bank_mask:0xf
    v_add_f32_dpp v77, v93, v77 row_ror:8 row_mask:0xf bank_mask:0xf
    v_add_f32_dpp v78, v94, v78 row_ror:8 row_mask:0xf bank_mask:0xf
    v_add_f32_dpp v79, v95, v79 row_ror:8 row_mask:0xf bank_mask:0xf
    v_mov_b32_dpp v64, v72 row_ror:8 row_mask:0xf bank_mask:0xc
    v_mov_b32_dpp v65, v73 row_ror:8 row_mask:0xf bank_mask:0xc
    v_mov_b32_dpp v66, v74 row_ror:8 row_mask:0xf bank_mask:0xc
    v_mov_b32_dpp v67, v75 row_ror:8 row_mask:0xf bank_mask:0xc
    v_mov_b32_dpp v68, v76 row_ror:8 row_mask:0xf bank_mask:0xc
    v_mov_b32_dpp v69, v77 row_ror:8 row_mask:0xf bank_mask:0xc
    v_mov_b32_dpp v70, v78 row_ror:8 row_mask:0xf bank_mask:0xc
    v_mov_b32_dpp v71, v79 row_ror:8 row_mask:0xf bank_mask:0xc
    v_bfi_b32 v64, s52, v3, v64
    v_bfi_b32 v65, s52, v3, v65
    v_bfi_b32 v66, s52, v3, v66
    v_bfi_b32 v67, s52, v3, v67
    v_bfi_b32 v68, s52, v3, v68
    v_bfi_b32 v69, s52, v3, v69
    v_bfi_b32 v70, s52, v3, v70
    v_bfi_b32 v71, s52, v3, v71
    s_waitcnt vmcnt(6)
    v_perm_b32 v32, v100, v96, s53
    v_perm_b32 v36, v100, v96, s54
    v_perm_b32 v40, v101, v97, s53
    v_perm_b32 v44, v101, v97, s54
    v_perm_b32 v48, v102, v98, s53
    v_perm_b32 v52, v102, v98, s54
    v_perm_b32 v56, v103, v99, s53
    v_perm_b32 v60, v103, v99, s54
    s_waitcnt vmcnt(4)
    v_perm_b32 v33, v108, v104, s53
    v_perm_b32 v37, v108, v104, s54
    v_perm_b32 v41, v109, v105, s53
    v_perm_b32 v45, v109, v105, s54
    v_perm_b32 v49, v110, v106, s53
    v_perm_b32 v53, v110, v106, s54
    v_perm_b32 v57, v111, v107, s53
    v_perm_b32 v61, v111, v107, s54
    s_waitcnt vmcnt(2)
    v_perm_b32 v34, v116, v112, s53
    v_perm_b32 v38, v116, v112, s54
    v_perm_b32 v42, v117, v113, s53
    v_perm_b32 v46, v117, v113, s54
    v_perm_b32 v50, v118, v114, s53
    v_perm_b32 v54, v118, v114, s54
    v_perm_b32 v58, v119, v115, s53
    v_perm_b32 v62, v119, v115, s54
    s_waitcnt vmcnt(0)
    v_perm_b32 v35, v124, v120, s53
    v_perm_b32 v39, v124, v120, s54
    v_perm_b32 v43, v125, v121, s53
    v_perm_b32 v47, v125, v121, s54
    v_perm_b32 v51, v126, v122, s53
    v_perm_b32 v55, v126, v122, s54
    v_perm_b32 v59, v127, v123, s53
    v_perm_b32 v63, v127, v123, s54
    buffer_store_dwordx4 v[64:67], v24, s[32:35], s68 offen
    buffer_store_dwordx4 v[68:71], v25, s[32:35], s68 offen
    v_mfma_f32_16x16x32_bf16 v[96:99], v[28:31], v[32:35], 0
    v_mfma_f32_16x16x32_bf16 v[100:103], v[28:31], v[36:39], 0
    v_mfma_f32_16x16x32_bf16 v[104:107], v[28:31], v[40:43], 0
    v_mfma_f32_16x16x32_bf16 v[108:111], v[28:31], v[44:47], 0
    v_mfma_f32_16x16x32_bf16 v[112:115], v[28:31], v[48:51], 0
    v_mfma_f32_16x16x32_bf16 v[116:119], v[28:31], v[52:55], 0
    v_mfma_f32_16x16x32_bf16 v[120:123], v[28:31], v[56:59], 0
    v_mfma_f32_16x16x32_bf16 v[124:127], v[28:31], v[60:63], 0
    s_nop 4
    v_permlane32_swap_b32 v96, v112
    v_permlane32_swap_b32 v97, v113
    v_permlane32_swap_b32 v98, v114
    v_permlane32_swap_b32 v99, v115
    v_permlane32_swap_b32 v100, v116
    v_permlane32_swap_b32 v101, v117
    v_permlane32_swap_b32 v102, v118
    v_permlane32_swap_b32 v103, v119
    v_permlane32_swap_b32 v104, v120
    v_permlane32_swap_b32 v105, v121
    v_permlane32_swap_b32 v106, v122
    v_permlane32_swap_b32 v107, v123
    v_permlane32_swap_b32 v108, v124
    v_permlane32_swap_b32 v109, v125
    v_permlane32_swap_b32 v110, v126
    v_permlane32_swap_b32 v111, v127
    v_add_f32_dpp v96, v112, v96 row_ror:8 row_mask:0xf bank_mask:0xf
    v_add_f32_dpp v97, v113, v97 row_ror:8 row_mask:0xf bank_mask:0xf
    v_add_f32_dpp v98, v114, v98 row_ror:8 row_mask:0xf bank_mask:0xf
    v_add_f32_dpp v99, v115, v99 row_ror:8 row_mask:0xf bank_mask:0xf
    v_add_f32_dpp v100, v116, v100 row_ror:8 row_mask:0xf bank_mask:0xf
    v_add_f32_dpp v101, v117, v101 row_ror:8 row_mask:0xf bank_mask:0xf
    v_add_f32_dpp v102, v118, v102 row_ror:8 row_mask:0xf bank_mask:0xf
    v_add_f32_dpp v103, v119, v103 row_ror:8 row_mask:0xf bank_mask:0xf
    v_add_f32_dpp v104, v120, v104 row_ror:8 row_mask:0xf bank_mask:0xf
    v_add_f32_dpp v105, v121, v105 row_ror:8 row_mask:0xf bank_mask:0xf
    v_add_f32_dpp v106, v122, v106 row_ror:8 row_mask:0xf bank_mask:0xf
    v_add_f32_dpp v107, v123, v107 row_ror:8 row_mask:0xf bank_mask:0xf
    v_add_f32_dpp v108, v124, v108 row_ror:8 row_mask:0xf bank_mask:0xf
    v_add_f32_dpp v109, v125, v109 row_ror:8 row_mask:0xf bank_mask:0xf
    v_add_f32_dpp v110, v126, v110 row_ror:8 row_mask:0xf bank_mask:0xf
    v_add_f32_dpp v111, v127, v111 row_ror:8 row_mask:0xf bank_mask:0xf
    v_mov_b32_dpp v96, v104 row_ror:8 row_mask:0xf bank_mask:0xc
    v_mov_b32_dpp v97, v105 row_ror:8 row_mask:0xf bank_mask:0xc
    v_mov_b32_dpp v98, v106 row_ror:8 row_mask:0xf bank_mask:0xc
    v_mov_b32_dpp v99, v107 row_ror:8 row_mask:0xf bank_mask:0xc
    v_mov_b32_dpp v100, v108 row_ror:8 row_mask:0xf bank_mask:0xc
    v_mov_b32_dpp v101, v109 row_ror:8 row_mask:0xf bank_mask:0xc
    v_mov_b32_dpp v102, v110 row_ror:8 row_mask:0xf bank_mask:0xc
    v_mov_b32_dpp v103, v111 row_ror:8 row_mask:0xf bank_mask:0xc
    v_bfi_b32 v96, s52, v3, v96
    v_bfi_b32 v97, s52, v3, v97
    v_bfi_b32 v98, s52, v3, v98
    v_bfi_b32 v99, s52, v3, v99
    v_bfi_b32 v100, s52, v3, v100
    v_bfi_b32 v101, s52, v3, v101
    v_bfi_b32 v102, s52, v3, v102
    v_bfi_b32 v103, s52, v3, v103
    buffer_store_dwordx4 v[96:99], v24, s[32:35], s69 offen
    buffer_store_dwordx4 v[100:103], v25, s[32:35], s69 offen
    s_cmp_eq_u32 s3, 1
    s_nop 0
    s_cbranch_scc1 LFX_49
    buffer_store_dwordx4 v[64:67], v24, s[32:35], s68 offen sc1
    buffer_store_dwordx4 v[68:71], v25, s[32:35], s68 offen sc1
    buffer_store_dwordx4 v[96:99], v24, s[32:35], s69 offen sc1
    buffer_store_dwordx4 v[100:103], v25, s[32:35], s69 offen sc1
    s_nop 1
LFX_49:
    s_mov_b32 s68, 7
    s_mul_i32 s56, s68, 4352
    v_lshrrev_b32 v4, 5, v0
    v_mul_u32_u24 v4, 1664, v4
    v_lshl_add_u32 v22, v0, 4, v4
    v_add_u32 v22, s56, v22
    v_lshrrev_b32 v4, 5, v0
    v_mul_u32_u24 v23, 17408, v4
    v_and_b32 v4, 31, v0
    v_lshl_add_u32 v23, v4, 4, v23
    s_mul_i32 s56, s68, 544
    v_add_u32 v23, s56, v23
    v_lshrrev_b32 v4, 3, v1
    v_lshlrev_b32 v24, 16, v4
    v_and_b32 v4, 1, v2
    v_lshl_add_u32 v24, v4, 12, v24
    v_and_b32 v4, 7, v1
    v_lshl_add_u32 v24, v4, 4, v24
    s_lshl_b32 s69, s48, 17
    s_lshl_b32 s56, s68, 13
    s_add_u32 s69, s69, s56
    s_lshl_b32 s56, s98, 7
    s_add_u32 s69, s69, s56
    s_add_u32 s69, s69, 7340032
    s_mov_b32 s52, 0x1ff
    s_branch L_WDf
L_WO:
    s_mov_b32 s40, s12
    s_mov_b32 s41, s13
    s_mov_b32 s42, 8388608
    s_mov_b32 s43, 0x20000
    s_lshl_b32 s67, s98, 1
    s_lshr_b32 s57, s50, 2
    s_add_u32 s67, s67, s57
    s_and_b32 s68, s50, 3
    s_lshr_b32 s56, s67, 2
    s_lshl_b32 s56, s56, 9
    s_and_b32 s57, s67, 3
    s_lshl_b32 s57, s57, 5
    s_add_u32 s56, s56, s57
    s_lshl_b32 s57, s68, 3
    s_add_u32 s56, s56, s57
    s_lshl_b32 s58, s56, 11
    s_lshl_b32 s57, s48, 8
    s_add_u32 s58, s58, s57
    v_lshlrev_b32 v25, 12, v2
    v_lshl_add_u32 v25, v1, 4, v25
    s_lshr_b32 s56, s50, 1
    s_and_b32 s56, s56, 1
    s_lshl_b32 s99, s98, 1
    s_add_u32 s99, s99, s56
    s_lshl_b32 s61, s48, 17
    s_lshl_b32 s57, s99, 12
    s_add_u32 s61, s61, s57
    s_add_u32 s61, s61, 4194304
    v_lshlrev_b32 v30, 4, v0
    s_mov_b32 s57, 112
    s_bitcmp1_b32 s57, s50
    s_cselect_b32 s56, 12, 144
    s_cselect_b32 s57, 4, 1
    s_mov_b32 s59, 15
    s_bitcmp1_b32 s59, s50
    s_cselect_b32 s56, 132, s56
    s_cselect_b32 s57, 8, s57
    v_mov_b32 v4, s56
    s_mov_b32 s65, 0
    s_nop 0
LW_50:
    ds_read_b32 v5, v4
    s_add_u32 s65, s65, 1
    s_cmp_gt_u32 s65, 4000000
    s_cbranch_scc1 L_end
    s_waitcnt lgkmcnt(0)
    v_readfirstlane_b32 s63, v5
    s_nop 0
    s_cmp_lt_u32 s63, s57
    s_nop 2
    s_cbranch_scc1 LW_50
    buffer_load_dwordx4 v[64:67], v25, s[40:43], s58 offen offset:0 nt
    s_add_u32 s62, s58, 262144
    buffer_load_dwordx4 v[68:71], v25, s[40:43], s62 offen nt
    s_add_u32 s62, s58, 524288
    buffer_load_dwordx4 v[72:75], v25, s[40:43], s62 offen nt
    s_add_u32 s62, s58, 786432
    buffer_load_dwordx4 v[76:79], v25, s[40:43], s62 offen nt
    buffer_load_dwordx4 v[80:83], v25, s[40:43], s58 offen offset:2048 nt
    s_add_u32 s62, s58, 264192
    buffer_load_dwordx4 v[84:87], v25, s[40:43], s62 offen nt
    s_add_u32 s62, s58, 526336
    buffer_load_dwordx4 v[88:91], v25, s[40:43], s62 offen nt
    s_add_u32 s62, s58, 788480
    buffer_load_dwordx4 v[92:95], v25, s[40:43], s62 offen nt
    s_cmp_eq_u32 s50, 4
    s_cbranch_scc1 L_OC
    s_cmp_eq_u32 s50, 6
    s_cbranch_scc1 L_ESst
L_WO2:
    s_lshl_b32 s59, s67, 9
    s_lshl_b32 s56, s68, 7
    s_add_u32 s59, s59, s56
    s_add_u32 s59, s59, 524288
    s_mul_i32 s56, s50, 4352
    v_lshrrev_b32 v4, 5, v0
    v_mul_u32_u24 v4, 1664, v4
    v_lshl_add_u32 v22, v0, 4, v4
    v_add_u32 v22, s56, v22
    v_lshrrev_b32 v4, 5, v0
    v_mul_u32_u24 v23, 17408, v4
    v_and_b32 v4, 31, v0
    v_lshl_add_u32 v23, v4, 4, v23
    s_mul_i32 s56, s50, 544
    v_add_u32 v23, s56, v23
    v_lshrrev_b32 v4, 3, v1
    v_lshlrev_b32 v24, 16, v4
    v_and_b32 v4, 1, v2
    v_lshl_add_u32 v24, v4, 12, v24
    v_and_b32 v4, 7, v1
    v_lshl_add_u32 v24, v4, 4, v24
    s_lshl_b32 s69, s48, 17
    s_lshl_b32 s56, s50, 13
    s_add_u32 s69, s69, s56
    s_lshl_b32 s56, s98, 7
    s_add_u32 s69, s69, s56
    s_add_u32 s69, s69, 6291456
    s_mov_b32 s52, 0x1ff
    v_and_b32 v6, 7, v1
    v_lshlrev_b32 v6, 14, v6
    v_lshl_add_u32 v6, v2, 5, v6
    v_lshrrev_b32 v4, 3, v1
    v_lshl_add_u32 v6, v4, 4, v6
    s_mov_b32 s36, s4
    s_mov_b32 s37, s5
    s_mov_b32 s38, 16384
    s_mov_b32 s39, 0x20000
    s_mov_b32 s44, s26
    s_mov_b32 s45, s27
    s_mov_b32 s46, 16384
    s_mov_b32 s47, 0x20000
    v_lshlrev_b32 v28, 11, v2
    v_and_b32 v4, 7, v0
    v_lshl_add_u32 v28, v4, 4, v28
    s_and_b32 s67, s99, 1
    s_lshl_b32 s67, s67, 13
    s_lshl_b32 s57, s48, 8
    s_add_u32 s67, s67, s57
    s_lshr_b32 s57, s99, 4
    s_lshl_b32 s57, s57, 7
    s_add_u32 s67, s67, s57
    s_and_b32 s57, s99, 14
    s_add_u32 s67, s67, s57
    buffer_load_ushort v27, v28, s[36:39], s67 offen
    v_bfe_u32 v4, v0, 2, 1
    v_lshlrev_b32 v29, 6, v4
    v_lshl_add_u32 v29, v2, 4, v29
    s_lshl_b32 s60, s48, 5
    s_add_u32 s60, s60, s99
    s_lshl_b32 s60, s60, 7
    s_add_u32 s60, s60, 131072
    v_mov_b32 v120, 0
    v_mov_b32 v121, 0
    v_mov_b32 v122, 0
    v_mov_b32 v123, 0
    v_mov_b32 v124, 0
    v_mov_b32 v125, 0
    v_mov_b32 v126, 0
    v_mov_b32 v127, 0
    v_mov_b32 v4, 96
    s_mov_b32 s65, 0
    s_nop 0
LW_51:
    ds_read_b32 v5, v4
    s_add_u32 s65, s65, 1
    s_cmp_gt_u32 s65, 4000000
    s_cbranch_scc1 L_end
    s_waitcnt lgkmcnt(0)
    v_readfirstlane_b32 s63, v5
    s_nop 0
    s_cmp_lt_u32 s63, 1
    s_nop 2
    s_cbranch_scc1 LW_51
    s_mov_b32 s3, s63
    v_mov_b32 v4, 144
    s_mov_b32 s65, 0
    s_nop 0
LW_52:
    ds_read_b32 v5, v4
    s_add_u32 s65, s65, 1
    s_cmp_gt_u32 s65, 4000000
    s_cbranch_scc1 L_end
    s_waitcnt lgkmcnt(0)
    v_readfirstlane_b32 s63, v5
    s_nop 0
    s_cmp_lt_u32 s63, 1
    s_nop 2
    s_cbranch_scc1 LW_52
    s_mov_b32 s65, 0
    buffer_load_dwordx4 v[8:11], v6, s[32:35], s59 offen sc1
    s_cmp_lg_u32 s50, 6
    s_cbranch_scc1 L_WO3
    s_waitcnt vmcnt(1)
L_WO3:
    s_waitcnt vmcnt(8)
    v_perm_b32 v32, v68, v64, s53
    v_perm_b32 v36, v68, v64, s54
    v_perm_b32 v40, v69, v65, s53
    v_perm_b32 v44, v69, v65, s54
    v_perm_b32 v48, v70, v66, s53
    v_perm_b32 v52, v70, v66, s54
    v_perm_b32 v56, v71, v67, s53
    v_perm_b32 v60, v71, v67, s54
    s_waitcnt vmcnt(6)
    v_perm_b32 v33, v76, v72, s53
    v_perm_b32 v37, v76, v72, s54
    v_perm_b32 v41, v77, v73, s53
    v_perm_b32 v45, v77, v73, s54
    v_perm_b32 v49, v78, v74, s53
    v_perm_b32 v53, v78, v74, s54
    v_perm_b32 v57, v79, v75, s53
    v_perm_b32 v61, v79, v75, s54
    s_waitcnt vmcnt(4)
    v_perm_b32 v34, v84, v80, s53
    v_perm_b32 v38, v84, v80, s54
    v_perm_b32 v42, v85, v81, s53
    v_perm_b32 v46, v85, v81, s54
    v_perm_b32 v50, v86, v82, s53
    v_perm_b32 v54, v86, v82, s54
    v_perm_b32 v58, v87, v83, s53
    v_perm_b32 v62, v87, v83, s54
    s_waitcnt vmcnt(2)
    v_perm_b32 v35, v92, v88, s53
    v_perm_b32 v39, v92, v88, s54
    v_perm_b32 v43, v93, v89, s53
    v_perm_b32 v47, v93, v89, s54
    v_perm_b32 v51, v94, v90, s53
    v_perm_b32 v55, v94, v90, s54
    v_perm_b32 v59, v95, v91, s53
    v_perm_b32 v63, v95, v91, s54
    s_sub_u32 s56, s50, 1
    s_cmp_ge_u32 s56, 2
    s_cbranch_scc1 L_WO1
    buffer_load_dwordx4 v[96:99], v30, s[32:35], s61 offen sc1
    buffer_load_dwordx4 v[100:103], v30, s[32:35], s61 offen offset:1024 sc1
    s_add_u32 s56, s61, 2097152
    buffer_load_dwordx4 v[104:107], v30, s[32:35], s56 offen sc1
    buffer_load_dwordx4 v[108:111], v30, s[32:35], s56 offen offset:1024 sc1
    s_waitcnt vmcnt(4)
    s_branch L_WO1b
L_WO1:
    s_waitcnt vmcnt(0)
L_WO1b:
    s_branch LC_55
LP_54:
    buffer_load_dwordx4 v[8:11], v6, s[32:35], s59 offen sc1
    s_add_u32 s65, s65, 1
    s_waitcnt vmcnt(0)
LC_55:
    v_xor_b32 v8, v3, v8
    v_xor_b32 v9, v3, v9
    v_xor_b32 v10, v3, v10
    v_xor_b32 v11, v3, v11
    v_or3_b32 v4, v8, v9, v10
    v_or_b32 v4, v4, v11
    v_and_b32 v4, 0xffff, v4
    v_cmp_ne_u32 vcc, 0, v4
    s_nop 4
    s_cbranch_vccz LD_53
    s_mov_b64 exec, vcc
    s_cmp_lt_u32 s65, 200000
    s_cbranch_scc1 LP_54
    s_branch L_end
LD_53:
    s_mov_b64 exec, -1
    v_perm_b32 v16, v9, v8, s54
    v_perm_b32 v17, v11, v10, s54
    s_nop 0
    v_mov_b32_dpp v120, v16 quad_perm:[0,1,2,3] row_mask:0xf bank_mask:0x3
    v_mov_b32_dpp v121, v17 quad_perm:[0,1,2,3] row_mask:0xf bank_mask:0x3
    v_mov_b32_dpp v122, v16 row_ror:8 row_mask:0xf bank_mask:0x3
    v_mov_b32_dpp v123, v17 row_ror:8 row_mask:0xf bank_mask:0x3
    s_nop 1
    v_mfma_f32_16x16x32_bf16 v[64:67], v[120:123], v[32:35], 0
    v_mov_b32_dpp v124, v16 row_ror:8 row_mask:0xf bank_mask:0xc
    v_mov_b32_dpp v125, v17 row_ror:8 row_mask:0xf bank_mask:0xc
    v_mov_b32_dpp v126, v16 quad_perm:[0,1,2,3] row_mask:0xf bank_mask:0xc
    v_mov_b32_dpp v127, v17 quad_perm:[0,1,2,3] row_mask:0xf bank_mask:0xc
    v_mfma_f32_16x16x32_bf16 v[68:71], v[120:123], v[36:39], 0
    v_mfma_f32_16x16x32_bf16 v[72:75], v[120:123], v[40:43], 0
    v_mfma_f32_16x16x32_bf16 v[76:79], v[120:123], v[44:47], 0
    v_mfma_f32_16x16x32_bf16 v[64:67], v[124:127], v[48:51], v[64:67]
    v_mfma_f32_16x16x32_bf16 v[68:71], v[124:127], v[52:55], v[68:71]
    v_mfma_f32_16x16x32_bf16 v[72:75], v[124:127], v[56:59], v[72:75]
    v_mfma_f32_16x16x32_bf16 v[76:79], v[124:127], v[60:63], v[76:79]
    s_nop 4
    ds_write_b128 v22, v[64:67] offset:6144
    ds_write_b128 v22, v[68:71] offset:6688
    ds_write_b128 v22, v[72:75] offset:7232
    ds_write_b128 v22, v[76:79] offset:7776
    s_waitcnt lgkmcnt(0)
    s_barrier
    ds_read_b128 v[32:35], v23 offset:6144
    ds_read_b128 v[36:39], v23 offset:10496
    ds_read_b128 v[40:43], v23 offset:14848
    ds_read_b128 v[44:47], v23 offset:19200
    s_waitcnt lgkmcnt(2)
    v_pk_add_f32 v[32:33], v[32:33], v[36:37]
    v_pk_add_f32 v[34:35], v[34:35], v[38:39]
    s_waitcnt lgkmcnt(0)
    v_pk_add_f32 v[40:41], v[40:41], v[44:45]
    v_pk_add_f32 v[42:43], v[42:43], v[46:47]
    v_pk_add_f32 v[32:33], v[32:33], v[40:41]
    v_pk_add_f32 v[34:35], v[34:35], v[42:43]
    s_nop 1
    v_permlane32_swap_b32 v32, v34
    v_permlane32_swap_b32 v33, v35
    v_add_f32 v32, v32, v34
    v_add_f32 v33, v33, v35
    v_bfi_b32 v32, s52, v3, v32
    v_bfi_b32 v33, s52, v3, v33
    v_mov_b32 v34, v32
    v_mov_b32 v35, v33
    s_nop 0
    v_permlane32_swap_b32 v32, v34
    v_permlane32_swap_b32 v33, v35
    s_mov_b32 exec_hi, 0
    buffer_store_dwordx4 v[32:35], v24, s[32:35], s69 offen
    s_cmp_eq_u32 s3, 1
    s_nop 0
    s_cbranch_scc1 LFX_56
    buffer_store_dwordx4 v[32:35], v24, s[32:35], s69 offen sc1
    s_nop 1
LFX_56:
    s_mov_b32 exec_hi, -1
    v_mov_b32 v4, 48
    v_mov_b32 v5, 1
    s_mov_b64 exec, 1
    ds_add_u32 v4, v5
    s_mov_b64 exec, -1
    s_cmp_gt_u32 s50, 2
    s_cbranch_scc1 L_fin
    s_cmp_lg_u32 s50, 0
    s_cbranch_scc1 L_RX
    s_cmp_ge_u32 s98, 14
    s_cselect_b32 s57, 16, 0
    s_sub_u32 s57, s2, s57
    s_add_u32 s57, s57, 128
    s_lshl_b32 s59, s57, 6
    s_add_u32 s59, s59, 65536
    s_add_u32 s100, s30, s59
    s_addc_u32 s101, s31, 0
    s_mov_b32 s65, 0
LS_57:
    s_load_dword s62, s[100:101], 0 glc
    s_add_u32 s65, s65, 1
    s_cmp_gt_u32 s65, 20000
    s_cbranch_scc1 LSD_58
    s_waitcnt lgkmcnt(0)
    s_xor_b32 s62, s62, s51
    s_and_b32 s62, s62, 0xff
    s_cbranch_scc1 LS_57
LSD_58:
    s_waitcnt lgkmcnt(0)
    v_mov_b32 v4, 112
    v_mov_b32 v5, 1
    s_mov_b64 exec, 1
    ds_add_u32 v4, v5
    s_mov_b64 exec, -1
    s_branch L_fin
L_RX:
    v_lshlrev_b32 v27, 16, v27
    v_mov_b32 v4, 48
    s_mov_b32 s65, 0
    s_nop 0
LW_59:
    ds_read_b32 v5, v4
    s_add_u32 s65, s65, 1
    s_cmp_gt_u32 s65, 4000000
    s_cbranch_scc1 L_end
    s_waitcnt lgkmcnt(0)
    v_readfirstlane_b32 s63, v5
    s_nop 0
    s_cmp_lt_u32 s63, 8
    s_nop 2
    s_cbranch_scc1 LW_59
    s_and_b32 s14, s51, 0xff
    s_mov_b32 s65, 0
    s_add_u32 s66, s61, 2097152
LP_61:
    buffer_load_dwordx4 v[96:99], v30, s[32:35], s61 offen sc1
    buffer_load_dwordx4 v[100:103], v30, s[32:35], s61 offen offset:1024 sc1
    buffer_load_dwordx4 v[104:107], v30, s[32:35], s66 offen sc1
    buffer_load_dwordx4 v[108:111], v30, s[32:35], s66 offen offset:1024 sc1
    s_add_u32 s65, s65, 1
    s_waitcnt vmcnt(3)
    v_xor_b32 v96, s14, v96
    v_xor_b32 v97, s14, v97
    v_xor_b32 v98, s14, v98
    v_xor_b32 v99, s14, v99
    v_or3_b32 v4, v96, v97, v98
    v_or_b32 v4, v4, v99
    s_waitcnt vmcnt(2)
    v_xor_b32 v100, s14, v100
    v_xor_b32 v101, s14, v101
    v_xor_b32 v102, s14, v102
    v_xor_b32 v103, s14, v103
    v_or3_b32 v4, v4, v100, v101
    v_or3_b32 v4, v4, v102, v103
    s_waitcnt vmcnt(1)
    v_xor_b32 v104, s14, v104
    v_xor_b32 v105, s14, v105
    v_xor_b32 v106, s14, v106
    v_xor_b32 v107, s14, v107
    v_or3_b32 v4, v4, v104, v105
    v_or3_b32 v4, v4, v106, v107
    s_waitcnt vmcnt(0)
    v_xor_b32 v108, s14, v108
    v_xor_b32 v109, s14, v109
    v_xor_b32 v110, s14, v110
    v_xor_b32 v111, s14, v111
    v_or3_b32 v4, v4, v108, v109
    v_or3_b32 v4, v4, v110, v111
    v_and_b32 v4, 0xff, v4
    v_cmp_ne_u32 vcc, 0, v4
    s_nop 4
    s_cbranch_vccz LD_60
    s_wqm_b64 exec, vcc
    s_cmp_lt_u32 s65, 200000
    s_cbranch_scc1 LP_61
    s_branch L_end
LD_60:
    s_mov_b64 exec, -1
    v_pk_add_f32 v[96:97], v[96:97], v[100:101]
    v_pk_add_f32 v[98:99], v[98:99], v[102:103]
    v_pk_add_f32 v[104:105], v[104:105], v[108:109]
    v_pk_add_f32 v[106:107], v[106:107], v[110:111]
    v_add_f32_dpp v96, v96, v96 row_ror:8 row_mask:0xf bank_mask:0xf
    v_add_f32_dpp v104, v104, v104 row_ror:8 row_mask:0xf bank_mask:0xf
    v_add_f32_dpp v97, v97, v97 row_ror:8 row_mask:0xf bank_mask:0xf
    v_add_f32_dpp v105, v105, v105 row_ror:8 row_mask:0xf bank_mask:0xf
    v_add_f32_dpp v98, v98, v98 row_ror:8 row_mask:0xf bank_mask:0xf
    v_add_f32_dpp v106, v106, v106 row_ror:8 row_mask:0xf bank_mask:0xf
    v_add_f32_dpp v99, v99, v99 row_ror:8 row_mask:0xf bank_mask:0xf
    v_add_f32_dpp v107, v107, v107 row_ror:8 row_mask:0xf bank_mask:0xf
    v_permlane32_swap_b32 v96, v104
    v_permlane32_swap_b32 v97, v105
    v_permlane32_swap_b32 v98, v106
    v_permlane32_swap_b32 v99, v107
    v_add_f32 v96, v96, v104
    v_add_f32 v97, v97, v105
    v_add_f32 v98, v98, v106
    v_add_f32 v99, v99, v107
    v_permlane16_swap_b32 v96, v97
    s_nop 0
    v_permlane16_swap_b32 v98, v99
    v_add_f32 v96, v96, v97
    v_add_f32 v98, v98, v99
    s_nop 1
    v_permlane32_swap_b32 v96, v98
    v_cvt_pk_bf16_f32 v4, v96, v98
    v_lshlrev_b32 v96, 16, v4
    v_and_b32 v98, 0xffff0000, v4
    v_mul_f32 v96, v96, v98
    v_cvt_pk_bf16_f32 v96, v96, v96
    v_and_b32 v96, 0xffff0000, v96
    v_add_f32 v27, v27, v96
    v_cvt_pk_bf16_f32 v27, v27, v27
    v_and_or_b32 v27, v27, s55, v3
    s_nop 1
    v_mov_b32_dpp v8, v27 quad_perm:[0,0,0,0] row_mask:0xf bank_mask:0xf
    v_mov_b32_dpp v9, v27 quad_perm:[1,1,1,1] row_mask:0xf bank_mask:0xf
    v_mov_b32_dpp v10, v27 quad_perm:[2,2,2,2] row_mask:0xf bank_mask:0xf
    v_mov_b32_dpp v11, v27 quad_perm:[3,3,3,3] row_mask:0xf bank_mask:0xf
    s_mov_b32 exec_lo, 0x110011
    s_mov_b32 exec_hi, 0x110011
    buffer_store_dwordx4 v[8:11], v29, s[32:35], s60 offen sc1
    s_mov_b64 exec, -1
    buffer_load_dwordx4 v[96:99], v30, s[32:35], s61 offen offset:2048 sc1
    buffer_load_dwordx4 v[100:103], v30, s[32:35], s61 offen offset:3072 sc1
    s_add_u32 s56, s61, 3145728
    buffer_load_dwordx4 v[104:107], v30, s[32:35], s56 offen sc1
    buffer_load_dwordx4 v[108:111], v30, s[32:35], s56 offen offset:1024 sc1
    v_mov_b32 v4, 52
    v_mov_b32 v5, 1
    s_mov_b64 exec, 1
    ds_add_u32 v4, v5
    s_mov_b64 exec, -1
    v_and_b32 v27, 0xffff0000, v27
    s_barrier
    v_mov_b32 v4, 64
    s_mov_b32 s65, 0
    s_nop 0
LW_62:
    ds_read_b32 v5, v4
    s_add_u32 s65, s65, 1
    s_cmp_gt_u32 s65, 4000000
    s_cbranch_scc1 L_end
    s_waitcnt lgkmcnt(0)
    v_readfirstlane_b32 s63, v5
    s_nop 0
    s_cmp_lt_u32 s63, 8
    s_nop 2
    s_cbranch_scc1 LW_62
    s_and_b32 s14, s51, 0xff
    s_mov_b32 s65, 0
    s_add_u32 s66, s61, 3145728
LP_64:
    buffer_load_dwordx4 v[96:99], v30, s[32:35], s61 offen offset:2048 sc1
    buffer_load_dwordx4 v[100:103], v30, s[32:35], s61 offen offset:3072 sc1
    buffer_load_dwordx4 v[104:107], v30, s[32:35], s66 offen sc1
    buffer_load_dwordx4 v[108:111], v30, s[32:35], s66 offen offset:1024 sc1
    s_add_u32 s65, s65, 1
    s_waitcnt vmcnt(3)
    v_xor_b32 v96, s14, v96
    v_xor_b32 v97, s14, v97
    v_xor_b32 v98, s14, v98
    v_xor_b32 v99, s14, v99
    v_or3_b32 v4, v96, v97, v98
    v_or_b32 v4, v4, v99
    s_waitcnt vmcnt(2)
    v_xor_b32 v100, s14, v100
    v_xor_b32 v101, s14, v101
    v_xor_b32 v102, s14, v102
    v_xor_b32 v103, s14, v103
    v_or3_b32 v4, v4, v100, v101
    v_or3_b32 v4, v4, v102, v103
    s_waitcnt vmcnt(1)
    v_xor_b32 v104, s14, v104
    v_xor_b32 v105, s14, v105
    v_xor_b32 v106, s14, v106
    v_xor_b32 v107, s14, v107
    v_or3_b32 v4, v4, v104, v105
    v_or3_b32 v4, v4, v106, v107
    s_waitcnt vmcnt(0)
    v_xor_b32 v108, s14, v108
    v_xor_b32 v109, s14, v109
    v_xor_b32 v110, s14, v110
    v_xor_b32 v111, s14, v111
    v_or3_b32 v4, v4, v108, v109
    v_or3_b32 v4, v4, v110, v111
    v_and_b32 v4, 0xff, v4
    v_cmp_ne_u32 vcc, 0, v4
    s_nop 4
    s_cbranch_vccz LD_63
    s_wqm_b64 exec, vcc
    s_cmp_lt_u32 s65, 200000
    s_cbranch_scc1 LP_64
    s_branch L_end
LD_63:
    s_mov_b64 exec, -1
    v_pk_add_f32 v[96:97], v[96:97], v[100:101]
    v_pk_add_f32 v[98:99], v[98:99], v[102:103]
    v_pk_add_f32 v[104:105], v[104:105], v[108:109]
    v_pk_add_f32 v[106:107], v[106:107], v[110:111]
    v_add_f32_dpp v96, v96, v96 row_ror:8 row_mask:0xf bank_mask:0xf
    v_add_f32_dpp v104, v104, v104 row_ror:8 row_mask:0xf bank_mask:0xf
    v_add_f32_dpp v97, v97, v97 row_ror:8 row_mask:0xf bank_mask:0xf
    v_add_f32_dpp v105, v105, v105 row_ror:8 row_mask:0xf bank_mask:0xf
    v_add_f32_dpp v98, v98, v98 row_ror:8 row_mask:0xf bank_mask:0xf
    v_add_f32_dpp v106, v106, v106 row_ror:8 row_mask:0xf bank_mask:0xf
    v_add_f32_dpp v99, v99, v99 row_ror:8 row_mask:0xf bank_mask:0xf
    v_add_f32_dpp v107, v107, v107 row_ror:8 row_mask:0xf bank_mask:0xf
    v_permlane32_swap_b32 v96, v104
    v_permlane32_swap_b32 v97, v105
    v_permlane32_swap_b32 v98, v106
    v_permlane32_swap_b32 v99, v107
    v_add_f32 v96, v96, v104
    v_add_f32 v97, v97, v105
    v_add_f32 v98, v98, v106
    v_add_f32 v99, v99, v107
    v_permlane16_swap_b32 v96, v97
    s_nop 0
    v_permlane16_swap_b32 v98, v99
    v_add_f32 v96, v96, v97
    v_add_f32 v98, v98, v99
    s_nop 1
    v_permlane32_swap_b32 v96, v98
    v_cvt_pk_bf16_f32 v4, v96, v98
    v_lshlrev_b32 v96, 16, v4
    v_and_b32 v98, 0xffff0000, v4
    v_mul_f32 v96, v96, v98
    v_cvt_pk_bf16_f32 v96, v96, v96
    v_and_b32 v96, 0xffff0000, v96
    v_add_f32 v27, v27, v96
    v_cvt_pk_bf16_f32 v27, v27, v27
    s_mov_b32 exec_lo, 0x00ff00ff
    s_mov_b32 exec_hi, 0x00ff00ff
    buffer_store_short v27, v28, s[44:47], s67 offen
    s_mov_b64 exec, -1
    s_cmp_lg_u32 s2, 0
    s_cbranch_scc1 L_fin
    s_cmp_lg_u32 s50, 1
    s_cbranch_scc1 L_fin
    s_add_u32 s56, s64, 1
    v_mov_b32 v4, s56
    v_mov_b32 v5, 0
    s_mov_b64 exec, 1
    buffer_store_dword v4, v5, s[32:35], 0 offen sc1
    s_mov_b64 exec, -1
    s_branch L_fin
L_LR:
    s_cmp_ge_u32 s50, 8
    s_cbranch_scc1 L_fin
    s_lshl_b32 s99, s98, 3
    s_add_u32 s99, s99, s50
    s_lshl_b32 s99, s99, 1
    s_sub_u32 s99, s99, 224
    s_lshl_b32 s59, s48, 17
    s_lshl_b32 s57, s99, 12
    s_add_u32 s59, s59, 5242880
    s_add_u32 s59, s59, s57
    v_lshlrev_b32 v6, 4, v0
    v_bfe_u32 v4, v0, 2, 2
    v_lshlrev_b32 v26, 6, v4
    v_lshl_add_u32 v26, v2, 4, v26
    s_lshl_b32 s60, s48, 5
    s_add_u32 s60, s60, s99
    s_lshl_b32 s60, s60, 7
    s_add_u32 s60, s60, 196608
    s_add_u32 s58, s60, 32768
    v_mov_b32 v4, 40
    s_mov_b32 s65, 0
    s_nop 0
LW_65:
    ds_read_b32 v5, v4
    s_add_u32 s65, s65, 1
    s_cmp_gt_u32 s65, 4000000
    s_cbranch_scc1 L_end
    s_waitcnt lgkmcnt(0)
    v_readfirstlane_b32 s63, v5
    s_nop 0
    s_cmp_lt_u32 s63, 2
    s_nop 2
    s_cbranch_scc1 LW_65
    s_and_b32 s14, s51, 0xff
    s_mov_b32 s65, 0
    s_add_u32 s66, s59, 4096
LP_67:
    buffer_load_dwordx4 v[64:67], v6, s[32:35], s59 offen sc1
    buffer_load_dwordx4 v[68:71], v6, s[32:35], s59 offen offset:1024 sc1
    buffer_load_dwordx4 v[72:75], v6, s[32:35], s59 offen offset:2048 sc1
    buffer_load_dwordx4 v[76:79], v6, s[32:35], s59 offen offset:3072 sc1
    buffer_load_dwordx4 v[80:83], v6, s[32:35], s66 offen sc1
    buffer_load_dwordx4 v[84:87], v6, s[32:35], s66 offen offset:1024 sc1
    buffer_load_dwordx4 v[88:91], v6, s[32:35], s66 offen offset:2048 sc1
    buffer_load_dwordx4 v[92:95], v6, s[32:35], s66 offen offset:3072 sc1
    s_add_u32 s65, s65, 1
    s_waitcnt vmcnt(7)
    v_xor_b32 v64, s14, v64
    v_xor_b32 v65, s14, v65
    v_xor_b32 v66, s14, v66
    v_xor_b32 v67, s14, v67
    v_or3_b32 v4, v64, v65, v66
    v_or_b32 v4, v4, v67
    s_waitcnt vmcnt(6)
    v_xor_b32 v68, s14, v68
    v_xor_b32 v69, s14, v69
    v_xor_b32 v70, s14, v70
    v_xor_b32 v71, s14, v71
    v_or3_b32 v4, v4, v68, v69
    v_or3_b32 v4, v4, v70, v71
    s_waitcnt vmcnt(5)
    v_xor_b32 v72, s14, v72
    v_xor_b32 v73, s14, v73
    v_xor_b32 v74, s14, v74
    v_xor_b32 v75, s14, v75
    v_or3_b32 v4, v4, v72, v73
    v_or3_b32 v4, v4, v74, v75
    s_waitcnt vmcnt(4)
    v_xor_b32 v76, s14, v76
    v_xor_b32 v77, s14, v77
    v_xor_b32 v78, s14, v78
    v_xor_b32 v79, s14, v79
    v_or3_b32 v4, v4, v76, v77
    v_or3_b32 v4, v4, v78, v79
    s_waitcnt vmcnt(3)
    v_xor_b32 v80, s14, v80
    v_xor_b32 v81, s14, v81
    v_xor_b32 v82, s14, v82
    v_xor_b32 v83, s14, v83
    v_or3_b32 v4, v4, v80, v81
    v_or3_b32 v4, v4, v82, v83
    s_waitcnt vmcnt(2)
    v_xor_b32 v84, s14, v84
    v_xor_b32 v85, s14, v85
    v_xor_b32 v86, s14, v86
    v_xor_b32 v87, s14, v87
    v_or3_b32 v4, v4, v84, v85
    v_or3_b32 v4, v4, v86, v87
    s_waitcnt vmcnt(1)
    v_xor_b32 v88, s14, v88
    v_xor_b32 v89, s14, v89
    v_xor_b32 v90, s14, v90
    v_xor_b32 v91, s14, v91
    v_or3_b32 v4, v4, v88, v89
    v_or3_b32 v4, v4, v90, v91
    s_waitcnt vmcnt(0)
    v_xor_b32 v92, s14, v92
    v_xor_b32 v93, s14, v93
    v_xor_b32 v94, s14, v94
    v_xor_b32 v95, s14, v95
    v_or3_b32 v4, v4, v92, v93
    v_or3_b32 v4, v4, v94, v95
    v_and_b32 v4, 0xff, v4
    v_cmp_ne_u32 vcc, 0, v4
    s_nop 4
    s_cbranch_vccz LD_66
    s_wqm_b64 exec, vcc
    s_cmp_lt_u32 s65, 200000
    s_cbranch_scc1 LP_67
    s_branch L_end
LD_66:
    s_mov_b64 exec, -1
    v_pk_add_f32 v[64:65], v[64:65], v[68:69]
    v_pk_add_f32 v[66:67], v[66:67], v[70:71]
    v_pk_add_f32 v[72:73], v[72:73], v[76:77]
    v_pk_add_f32 v[74:75], v[74:75], v[78:79]
    v_pk_add_f32 v[80:81], v[80:81], v[84:85]
    v_pk_add_f32 v[82:83], v[82:83], v[86:87]
    v_pk_add_f32 v[88:89], v[88:89], v[92:93]
    v_pk_add_f32 v[90:91], v[90:91], v[94:95]
    v_add_f32_dpp v64, v64, v64 row_ror:8 row_mask:0xf bank_mask:0x3
    v_add_f32_dpp v65, v65, v65 row_ror:8 row_mask:0xf bank_mask:0x3
    v_add_f32_dpp v66, v66, v66 row_ror:8 row_mask:0xf bank_mask:0x3
    v_add_f32_dpp v67, v67, v67 row_ror:8 row_mask:0xf bank_mask:0x3
    v_add_f32_dpp v72, v72, v72 row_ror:8 row_mask:0xf bank_mask:0x3
    v_add_f32_dpp v73, v73, v73 row_ror:8 row_mask:0xf bank_mask:0x3
    v_add_f32_dpp v74, v74, v74 row_ror:8 row_mask:0xf bank_mask:0x3
    v_add_f32_dpp v75, v75, v75 row_ror:8 row_mask:0xf bank_mask:0x3
    v_add_f32_dpp v64, v80, v80 row_ror:8 row_mask:0xf bank_mask:0xc
    v_add_f32_dpp v65, v81, v81 row_ror:8 row_mask:0xf bank_mask:0xc
    v_add_f32_dpp v66, v82, v82 row_ror:8 row_mask:0xf bank_mask:0xc
    v_add_f32_dpp v67, v83, v83 row_ror:8 row_mask:0xf bank_mask:0xc
    v_add_f32_dpp v72, v88, v88 row_ror:8 row_mask:0xf bank_mask:0xc
    v_add_f32_dpp v73, v89, v89 row_ror:8 row_mask:0xf bank_mask:0xc
    v_add_f32_dpp v74, v90, v90 row_ror:8 row_mask:0xf bank_mask:0xc
    v_add_f32_dpp v75, v91, v91 row_ror:8 row_mask:0xf bank_mask:0xc
    v_permlane32_swap_b32 v64, v72
    v_permlane32_swap_b32 v65, v73
    v_permlane32_swap_b32 v66, v74
    v_permlane32_swap_b32 v67, v75
    v_pk_add_f32 v[64:65], v[64:65], v[72:73]
    v_pk_add_f32 v[66:67], v[66:67], v[74:75]
    s_nop 0
    v_permlane16_swap_b32 v64, v65
    v_permlane16_swap_b32 v66, v67
    v_add_f32 v64, v64, v65
    v_add_f32 v66, v66, v67
    s_nop 1
    v_permlane32_swap_b32 v64, v66
    v_cvt_pk_bf16_f32 v66, v66, v66
    v_and_b32 v66, 0xffff0000, v66
    v_add_f32 v66, 1.0, v66
    v_cvt_pk_bf16_f32 v64, v64, v64
    v_and_or_b32 v64, v64, s55, v3
    v_cvt_pk_bf16_f32 v66, v66, v66
    v_and_or_b32 v66, v66, s55, v3
    v_mov_b32_dpp v8, v64 quad_perm:[0,0,0,0] row_mask:0xf bank_mask:0xf
    v_mov_b32_dpp v9, v64 quad_perm:[1,1,1,1] row_mask:0xf bank_mask:0xf
    v_mov_b32_dpp v10, v64 quad_perm:[2,2,2,2] row_mask:0xf bank_mask:0xf
    v_mov_b32_dpp v11, v64 quad_perm:[3,3,3,3] row_mask:0xf bank_mask:0xf
    v_mov_b32_dpp v12, v66 quad_perm:[0,0,0,0] row_mask:0xf bank_mask:0xf
    v_mov_b32_dpp v13, v66 quad_perm:[1,1,1,1] row_mask:0xf bank_mask:0xf
    v_mov_b32_dpp v14, v66 quad_perm:[2,2,2,2] row_mask:0xf bank_mask:0xf
    v_mov_b32_dpp v15, v66 quad_perm:[3,3,3,3] row_mask:0xf bank_mask:0xf
    s_mov_b32 exec_lo, 0x11111111
    s_mov_b32 exec_hi, 0x11111111
    buffer_store_dwordx4 v[8:11], v26, s[32:35], s60 offen sc1
    buffer_store_dwordx4 v[12:15], v26, s[32:35], s58 offen sc1
    s_mov_b64 exec, -1
    v_mov_b32 v4, 144
    v_mov_b32 v5, 1
    s_mov_b64 exec, 1
    ds_add_u32 v4, v5
    s_mov_b64 exec, -1
    s_sub_u32 s98, s98, 2
    s_branch L_F2b
L_PF:
    s_add_u32 s59, s59, 3670016
    v_mov_b32 v4, 56
    s_mov_b32 s65, 0
    s_nop 0
LW_68:
    ds_read_b32 v5, v4
    s_add_u32 s65, s65, 1
    s_cmp_gt_u32 s65, 4000000
    s_cbranch_scc1 L_end
    s_waitcnt lgkmcnt(0)
    v_readfirstlane_b32 s63, v5
    s_nop 0
    s_cmp_lt_u32 s63, 2
    s_nop 2
    s_cbranch_scc1 LW_68
    v_mov_b32 v4, 144
    s_mov_b32 s65, 0
    s_nop 0
LW_69:
    ds_read_b32 v5, v4
    s_add_u32 s65, s65, 1
    s_cmp_gt_u32 s65, 4000000
    s_cbranch_scc1 L_end
    s_waitcnt lgkmcnt(0)
    v_readfirstlane_b32 s63, v5
    s_nop 0
    s_cmp_lt_u32 s63, 8
    s_nop 2
    s_cbranch_scc1 LW_69
    buffer_load_dwordx4 v[64:67], v7, s[36:39], s59 offen offset:0
    s_add_u32 s62, s59, 57344
    buffer_load_dwordx4 v[68:71], v7, s[36:39], s62 offen
    s_add_u32 s62, s59, 114688
    buffer_load_dwordx4 v[72:75], v7, s[36:39], s62 offen
    s_add_u32 s62, s59, 172032
    buffer_load_dwordx4 v[76:79], v7, s[36:39], s62 offen
    s_add_u32 s62, s59, 229376
    buffer_load_dwordx4 v[80:83], v7, s[36:39], s62 offen
    s_add_u32 s62, s59, 286720
    buffer_load_dwordx4 v[84:87], v7, s[36:39], s62 offen
    s_add_u32 s62, s59, 344064
    buffer_load_dwordx4 v[88:91], v7, s[36:39], s62 offen
    s_add_u32 s62, s59, 401408
    buffer_load_dwordx4 v[92:95], v7, s[36:39], s62 offen
    s_waitcnt vmcnt(0)
    s_branch L_fin
L_F2:
    s_cmp_ge_u32 s98, 14
    s_cbranch_scc1 L_LR
L_F2b:
    s_add_u32 s56, s48, 3
    s_and_b32 s56, s56, 7
    s_lshr_b32 s57, s98, 1
    s_add_u32 s56, s56, s57
    s_add_u32 s56, s56, 1
    s_cmp_ge_u32 s56, 7
    s_cselect_b32 s57, 7, 0
    s_sub_u32 s56, s56, s57
    s_cmp_ge_u32 s56, 7
    s_cselect_b32 s57, 7, 0
    s_sub_u32 s56, s56, s57
    s_mul_i32 s68, s48, 7
    s_add_u32 s68, s68, s56
    s_lshl_b32 s68, s68, 1
    s_and_b32 s57, s98, 1
    s_add_u32 s68, s68, s57
    s_and_b32 s69, s68, 1
    s_cmp_eq_u32 s69, 1
    s_cselect_b32 s36, s18, s16
    s_cselect_b32 s37, s19, s17
    s_mov_b32 s38, 7340032
    s_mov_b32 s39, 0x20000
    v_lshrrev_b32 v5, 3, v1
    v_lshl_add_u32 v5, v5, 2, v2
    s_mov_b32 s62, 7168
    v_mul_lo_u32 v5, v5, s62
    v_and_b32 v7, 7, v1
    v_lshl_add_u32 v7, v7, 4, v5
    s_mul_i32 s59, s50, 458752
    s_lshr_b32 s57, s68, 1
    s_lshl_b32 s57, s57, 7
    s_add_u32 s59, s59, s57
    s_cmp_ge_u32 s49, 30
    s_cbranch_scc1 L_PF
    v_mov_b32 v4, 40
    s_mov_b32 s65, 0
    s_nop 0
LW_70:
    ds_read_b32 v5, v4
    s_add_u32 s65, s65, 1
    s_cmp_gt_u32 s65, 4000000
    s_cbranch_scc1 L_end
    s_waitcnt lgkmcnt(0)
    v_readfirstlane_b32 s63, v5
    s_nop 0
    s_cmp_lt_u32 s63, 2
    s_nop 2
    s_cbranch_scc1 LW_70
    v_mov_b32 v4, 120
    s_mov_b32 s65, 0
    s_nop 0
LW_71:
    ds_read_b32 v5, v4
    s_add_u32 s65, s65, 1
    s_cmp_gt_u32 s65, 4000000
    s_cbranch_scc1 L_end
    s_waitcnt lgkmcnt(0)
    v_readfirstlane_b32 s63, v5
    s_nop 0
    s_cmp_lt_u32 s63, 2
    s_nop 2
    s_cbranch_scc1 LW_71
    buffer_load_dwordx4 v[64:67], v7, s[36:39], s59 offen offset:0 nt
    s_add_u32 s62, s59, 57344
    buffer_load_dwordx4 v[68:71], v7, s[36:39], s62 offen nt
    s_add_u32 s62, s59, 114688
    buffer_load_dwordx4 v[72:75], v7, s[36:39], s62 offen nt
    s_add_u32 s62, s59, 172032
    buffer_load_dwordx4 v[76:79], v7, s[36:39], s62 offen nt
    s_add_u32 s62, s59, 229376
    buffer_load_dwordx4 v[80:83], v7, s[36:39], s62 offen nt
    s_add_u32 s62, s59, 286720
    buffer_load_dwordx4 v[84:87], v7, s[36:39], s62 offen nt
    s_add_u32 s62, s59, 344064
    buffer_load_dwordx4 v[88:91], v7, s[36:39], s62 offen nt
    s_add_u32 s62, s59, 401408
    buffer_load_dwordx4 v[92:95], v7, s[36:39], s62 offen nt
    s_lshl_b32 s61, s2, 6
    s_add_u32 s61, s61, 65536
    v_lshrrev_b32 v5, 3, v1
    v_and_b32 v26, 1, v2
    v_lshl_add_u32 v5, v5, 2, v26
    v_lshlrev_b32 v5, 8, v5
    v_and_b32 v26, 3, v1
    v_lshl_add_u32 v26, v26, 4, v5
    v_bfe_u32 v5, v1, 2, 1
    v_lshl_add_u32 v26, v5, 7, v26
    v_lshrrev_b32 v5, 1, v2
    v_lshl_add_u32 v26, v5, 6, v26
    v_lshrrev_b32 v30, 3, v1
    v_and_b32 v31, 7, v1
    s_mov_b32 s56, -0x8400
    v_mul_lo_u32 v27, v30, s56
    v_add_u32 v27, v27, v26
    v_add_u32 v27, 32768, v27
    v_mul_u32_u24 v22, 272, v31
    v_and_b32 v4, 1, v2
    v_lshl_add_u32 v22, v4, 7, v22
    v_lshl_add_u32 v22, v30, 6, v22
    v_lshrrev_b32 v4, 1, v2
    v_mul_u32_u24 v4, 34816, v4
    s_mul_i32 s56, s50, 2176
    v_add3_u32 v22, v22, v4, s56
    v_mul_u32_u24 v23, 8704, v2
    v_lshl_add_u32 v23, v1, 4, v23
    s_mul_i32 s56, s50, 272
    v_add_u32 v23, s56, v23
    v_add_u32 v28, 75776, v23
    v_mul_u32_u24 v25, 272, v31
    v_lshl_add_u32 v25, v30, 6, v25
    s_lshl_b32 s56, s50, 2
    s_add_u32 s56, s56, 2048
    v_add_u32 v25, s56, v25
    v_lshrrev_b32 v4, 2, v31
    v_lshlrev_b32 v24, 7, v30
    v_sub_u32 v24, 0x100, v24
    v_mul_u32_u24 v4, v24, v4
    v_add_u32 v25, v25, v4
    v_lshl_add_u32 v4, v30, 2, v2
    v_mul_u32_u24 v29, 272, v4
    v_lshl_add_u32 v29, v31, 5, v29
    v_mul_u32_u24 v24, 0xc0, v30
    v_add_u32 v29, v29, v24
    v_lshlrev_b32 v24, 5, v4
    v_lshl_add_u32 v24, v31, 2, v24
    s_lshl_b32 s67, s50, 11
    s_add_u32 s59, s67, 196608
    s_lshl_b32 s60, s68, 11
    s_lshl_b32 s57, s50, 8
    s_add_u32 s60, s60, s57
    s_add_u32 s60, s60, 655360
    s_cmp_lg_u32 s50, 3
    s_cbranch_scc1 L_GUw
    s_and_b32 s58, s48, 1
    s_lshl_b32 s58, s58, 15
    s_lshl_b32 s57, s98, 7
    s_add_u32 s58, s58, s57
    s_add_u32 s58, s58, 202752
    s_add_u32 s100, s30, s58
    s_addc_u32 s101, s31, 0
    s_mov_b32 s65, 0
LS_72:
    s_load_dword s62, s[100:101], 0 glc
    s_load_dword s63, s[100:101], 16384 glc
    s_add_u32 s65, s65, 1
    s_cmp_gt_u32 s65, 20000
    s_cbranch_scc1 LSD_73
    s_waitcnt lgkmcnt(0)
    s_xor_b32 s62, s62, s51
    s_xor_b32 s63, s63, s51
    s_or_b32 s62, s62, s63
    s_and_b32 s62, s62, 0xff
    s_cbranch_scc1 LS_72
LSD_73:
    s_waitcnt lgkmcnt(0)
    v_mov_b32 v4, 84
    v_mov_b32 v5, 1
    s_mov_b64 exec, 1
    ds_add_u32 v4, v5
    s_mov_b64 exec, -1
L_GUw:
    v_mov_b32 v4, 84
    s_mov_b32 s65, 0
    s_nop 0
LW_74:
    ds_read_b32 v5, v4
    s_add_u32 s65, s65, 1
    s_cmp_gt_u32 s65, 4000000
    s_cbranch_scc1 L_end
    s_waitcnt lgkmcnt(0)
    v_readfirstlane_b32 s63, v5
    s_nop 0
    s_cmp_lt_u32 s63, 1
    s_nop 2
    s_cbranch_scc1 LW_74
    s_mov_b32 s65, 0
    buffer_load_dwordx4 v[96:99], v27, s[32:35], s59 offen sc1
    buffer_load_dwordx4 v[100:103], v27, s[32:35], s59 offen offset:512 sc1
    buffer_load_dwordx4 v[104:107], v27, s[32:35], s59 offen offset:1024 sc1
    buffer_load_dwordx4 v[108:111], v27, s[32:35], s59 offen offset:1536 sc1
    s_waitcnt vmcnt(10)
    v_perm_b32 v32, v68, v64, s53
    v_perm_b32 v36, v68, v64, s54
    v_perm_b32 v40, v69, v65, s53
    v_perm_b32 v44, v69, v65, s54
    v_perm_b32 v48, v70, v66, s53
    v_perm_b32 v52, v70, v66, s54
    v_perm_b32 v56, v71, v67, s53
    v_perm_b32 v60, v71, v67, s54
    s_waitcnt vmcnt(8)
    v_perm_b32 v33, v76, v72, s53
    v_perm_b32 v37, v76, v72, s54
    v_perm_b32 v41, v77, v73, s53
    v_perm_b32 v45, v77, v73, s54
    v_perm_b32 v49, v78, v74, s53
    v_perm_b32 v53, v78, v74, s54
    v_perm_b32 v57, v79, v75, s53
    v_perm_b32 v61, v79, v75, s54
    s_waitcnt vmcnt(6)
    v_perm_b32 v34, v84, v80, s53
    v_perm_b32 v38, v84, v80, s54
    v_perm_b32 v42, v85, v81, s53
    v_perm_b32 v46, v85, v81, s54
    v_perm_b32 v50, v86, v82, s53
    v_perm_b32 v54, v86, v82, s54
    v_perm_b32 v58, v87, v83, s53
    v_perm_b32 v62, v87, v83, s54
    s_waitcnt vmcnt(4)
    v_perm_b32 v35, v92, v88, s53
    v_perm_b32 v39, v92, v88, s54
    v_perm_b32 v43, v93, v89, s53
    v_perm_b32 v47, v93, v89, s54
    v_perm_b32 v51, v94, v90, s53
    v_perm_b32 v55, v94, v90, s54
    v_perm_b32 v59, v95, v91, s53
    v_perm_b32 v63, v95, v91, s54
    v_mov_b32 v64, v32
    v_mov_b32 v65, v33
    v_mov_b32 v66, v34
    v_mov_b32 v67, v35
    v_mov_b32 v68, v36
    v_mov_b32 v69, v37
    v_mov_b32 v70, v38
    v_mov_b32 v71, v39
    v_mov_b32 v72, v40
    v_mov_b32 v73, v41
    v_mov_b32 v74, v42
    v_mov_b32 v75, v43
    v_mov_b32 v76, v44
    v_mov_b32 v77, v45
    v_mov_b32 v78, v46
    v_mov_b32 v79, v47
    v_mov_b32_dpp v32, v48 row_ror:8 row_mask:0xf bank_mask:0xc
    v_mov_b32_dpp v33, v49 row_ror:8 row_mask:0xf bank_mask:0xc
    v_mov_b32_dpp v34, v50 row_ror:8 row_mask:0xf bank_mask:0xc
    v_mov_b32_dpp v35, v51 row_ror:8 row_mask:0xf bank_mask:0xc
    v_mov_b32_dpp v36, v52 row_ror:8 row_mask:0xf bank_mask:0xc
    v_mov_b32_dpp v37, v53 row_ror:8 row_mask:0xf bank_mask:0xc
    v_mov_b32_dpp v38, v54 row_ror:8 row_mask:0xf bank_mask:0xc
    v_mov_b32_dpp v39, v55 row_ror:8 row_mask:0xf bank_mask:0xc
    v_mov_b32_dpp v40, v56 row_ror:8 row_mask:0xf bank_mask:0xc
    v_mov_b32_dpp v41, v57 row_ror:8 row_mask:0xf bank_mask:0xc
    v_mov_b32_dpp v42, v58 row_ror:8 row_mask:0xf bank_mask:0xc
    v_mov_b32_dpp v43, v59 row_ror:8 row_mask:0xf bank_mask:0xc
    v_mov_b32_dpp v44, v60 row_ror:8 row_mask:0xf bank_mask:0xc
    v_mov_b32_dpp v45, v61 row_ror:8 row_mask:0xf bank_mask:0xc
    v_mov_b32_dpp v46, v62 row_ror:8 row_mask:0xf bank_mask:0xc
    v_mov_b32_dpp v47, v63 row_ror:8 row_mask:0xf bank_mask:0xc
    v_mov_b32_dpp v48, v64 row_ror:8 row_mask:0xf bank_mask:0x3
    v_mov_b32_dpp v49, v65 row_ror:8 row_mask:0xf bank_mask:0x3
    v_mov_b32_dpp v50, v66 row_ror:8 row_mask:0xf bank_mask:0x3
    v_mov_b32_dpp v51, v67 row_ror:8 row_mask:0xf bank_mask:0x3
    v_mov_b32_dpp v52, v68 row_ror:8 row_mask:0xf bank_mask:0x3
    v_mov_b32_dpp v53, v69 row_ror:8 row_mask:0xf bank_mask:0x3
    v_mov_b32_dpp v54, v70 row_ror:8 row_mask:0xf bank_mask:0x3
    v_mov_b32_dpp v55, v71 row_ror:8 row_mask:0xf bank_mask:0x3
    v_mov_b32_dpp v56, v72 row_ror:8 row_mask:0xf bank_mask:0x3
    v_mov_b32_dpp v57, v73 row_ror:8 row_mask:0xf bank_mask:0x3
    v_mov_b32_dpp v58, v74 row_ror:8 row_mask:0xf bank_mask:0x3
    v_mov_b32_dpp v59, v75 row_ror:8 row_mask:0xf bank_mask:0x3
    v_mov_b32_dpp v60, v76 row_ror:8 row_mask:0xf bank_mask:0x3
    v_mov_b32_dpp v61, v77 row_ror:8 row_mask:0xf bank_mask:0x3
    v_mov_b32_dpp v62, v78 row_ror:8 row_mask:0xf bank_mask:0x3
    v_mov_b32_dpp v63, v79 row_ror:8 row_mask:0xf bank_mask:0x3
    s_nop 1
    s_branch LC_77
LP_76:
    buffer_load_dwordx4 v[96:99], v27, s[32:35], s59 offen sc1
    buffer_load_dwordx4 v[100:103], v27, s[32:35], s59 offen offset:512 sc1
    buffer_load_dwordx4 v[104:107], v27, s[32:35], s59 offen offset:1024 sc1
    buffer_load_dwordx4 v[108:111], v27, s[32:35], s59 offen offset:1536 sc1
LC_77:
    s_add_u32 s65, s65, 1
    s_waitcnt vmcnt(3)
    v_xor_b32 v96, v3, v96
    v_xor_b32 v97, v3, v97
    v_xor_b32 v98, v3, v98
    v_xor_b32 v99, v3, v99
    v_or3_b32 v4, v96, v97, v98
    v_or_b32 v4, v4, v99
    s_waitcnt vmcnt(2)
    v_xor_b32 v100, v3, v100
    v_xor_b32 v101, v3, v101
    v_xor_b32 v102, v3, v102
    v_xor_b32 v103, v3, v103
    v_or3_b32 v4, v4, v100, v101
    v_or3_b32 v4, v4, v102, v103
    s_waitcnt vmcnt(1)
    v_xor_b32 v104, v3, v104
    v_xor_b32 v105, v3, v105
    v_xor_b32 v106, v3, v106
    v_xor_b32 v107, v3, v107
    v_or3_b32 v4, v4, v104, v105
    v_or3_b32 v4, v4, v106, v107
    s_waitcnt vmcnt(0)
    v_xor_b32 v108, v3, v108
    v_xor_b32 v109, v3, v109
    v_xor_b32 v110, v3, v110
    v_xor_b32 v111, v3, v111
    v_or3_b32 v4, v4, v108, v109
    v_or3_b32 v4, v4, v110, v111
    v_and_b32 v4, 0xffff, v4
    v_cmp_ne_u32 vcc, 0, v4
    s_nop 4
    s_cbranch_vccz LD_75
    s_mov_b64 exec, vcc
    s_cmp_lt_u32 s65, 200000
    s_cbranch_scc1 LP_76
    s_branch L_end
LD_75:
    s_mov_b64 exec, -1
    v_perm_b32 v16, v97, v96, s54
    v_perm_b32 v17, v99, v98, s54
    v_perm_b32 v18, v101, v100, s54
    v_perm_b32 v19, v103, v102, s54
    v_perm_b32 v8, v105, v104, s54
    v_perm_b32 v9, v107, v106, s54
    v_perm_b32 v10, v109, v108, s54
    v_perm_b32 v11, v111, v110, s54
    v_permlane32_swap_b32 v16, v18
    v_permlane32_swap_b32 v17, v19
    v_permlane32_swap_b32 v8, v10
    v_permlane32_swap_b32 v9, v11
    v_mfma_f32_16x16x32_bf16 v[112:115], v[16:19], v[32:35], 0
    v_mfma_f32_16x16x32_bf16 v[116:119], v[16:19], v[36:39], 0
    v_mfma_f32_16x16x32_bf16 v[120:123], v[16:19], v[40:43], 0
    v_mfma_f32_16x16x32_bf16 v[124:127], v[16:19], v[44:47], 0
    v_mfma_f32_16x16x32_bf16 v[112:115], v[8:11], v[48:51], v[112:115]
    v_mfma_f32_16x16x32_bf16 v[116:119], v[8:11], v[52:55], v[116:119]
    v_mfma_f32_16x16x32_bf16 v[120:123], v[8:11], v[56:59], v[120:123]
    v_mfma_f32_16x16x32_bf16 v[124:127], v[8:11], v[60:63], v[124:127]
    v_mov_b32_dpp v96, v104 row_ror:8 row_mask:0xf bank_mask:0xc
    v_mov_b32_dpp v97, v105 row_ror:8 row_mask:0xf bank_mask:0xc
    v_mov_b32_dpp v98, v106 row_ror:8 row_mask:0xf bank_mask:0xc
    v_mov_b32_dpp v99, v107 row_ror:8 row_mask:0xf bank_mask:0xc
    v_mov_b32_dpp v100, v108 row_ror:8 row_mask:0xf bank_mask:0xc
    v_mov_b32_dpp v101, v109 row_ror:8 row_mask:0xf bank_mask:0xc
    v_mov_b32_dpp v102, v110 row_ror:8 row_mask:0xf bank_mask:0xc
    v_mov_b32_dpp v103, v111 row_ror:8 row_mask:0xf bank_mask:0xc
    v_mov_b32 v88, 0x3f803f80
    v_mov_b32 v89, 0x3f803f80
    v_mov_b32 v90, 0x3f803f80
    v_mov_b32 v91, 0x3f803f80
    ds_write_b128 v22, v[112:115] offset:40960
    ds_write_b128 v22, v[116:119] offset:40976
    ds_write_b128 v22, v[120:123] offset:40992
    ds_write_b128 v22, v[124:127] offset:41008
    v_mov_b32 v4, 28
    v_mov_b32 v5, 1
    s_mov_b64 exec, 1
    ds_add_u32 v4, v5
    s_mov_b64 exec, -1
    v_lshrrev_b32 v4, 1, v2
    v_mul_u32_u24 v4, 34784, v4
    v_sub_u32 v22, v22, v4
    s_mov_b32 s6, 0x22222222
    s_mov_b32 s7, 0x22222222
    s_mov_b32 s8, 0x44444444
    s_mov_b32 s9, 0x44444444
    s_mov_b32 s10, 0x88888888
    s_mov_b32 s11, 0x88888888
    s_add_u32 s59, s67, 131072
    v_mov_b32 v21, 0
    s_cmp_lg_u32 s50, 0
    s_nop 0
    s_cbranch_scc1 L_GUx
    s_lshl_b32 s58, s48, 5
    s_add_u32 s58, s58, s98
    s_lshl_b32 s58, s58, 7
    s_add_u32 s58, s58, 131072
    v_mov_b32 v5, 0
    s_mov_b32 s65, 0
    s_mov_b64 exec, 1
LV_78:
    buffer_load_dword v6, v5, s[32:35], s58 offen sc1
    s_add_u32 s65, s65, 1
    s_waitcnt vmcnt(0)
    v_xor_b32 v6, v3, v6
    v_and_b32 v6, 0xff, v6
    v_cmp_ne_u32 vcc, 0, v6
    s_nop 4
    s_cbranch_vccz LVD_79
    s_cmp_lt_u32 s65, 20000
    s_cbranch_scc1 LV_78
LVD_79:
    s_mov_b64 exec, -1
    v_mov_b32 v4, 88
    v_mov_b32 v5, 1
    s_mov_b64 exec, 1
    ds_add_u32 v4, v5
    s_mov_b64 exec, -1
L_GUx:
    v_mov_b32 v4, 88
    s_mov_b32 s65, 0
    s_nop 0
LW_80:
    ds_read_b32 v5, v4
    s_add_u32 s65, s65, 1
    s_cmp_gt_u32 s65, 4000000
    s_cbranch_scc1 L_end
    s_waitcnt lgkmcnt(0)
    v_readfirstlane_b32 s63, v5
    s_nop 0
    s_cmp_lt_u32 s63, 1
    s_nop 2
    s_cbranch_scc1 LW_80
    s_mov_b32 s65, 0
    buffer_load_dwordx4 v[80:83], v26, s[32:35], s59 offen sc1
    buffer_load_dwordx4 v[84:87], v26, s[32:35], s59 offen offset:512 sc1
    s_cmp_ge_u32 s50, 8
    s_cbranch_scc1 L_GUh
    v_mov_b32 v4, 28
    s_mov_b32 s65, 0
    s_nop 0
LW_84:
    ds_read_b32 v5, v4
    s_add_u32 s65, s65, 1
    s_cmp_gt_u32 s65, 4000000
    s_cbranch_scc1 L_end
    s_waitcnt lgkmcnt(0)
    v_readfirstlane_b32 s63, v5
    s_nop 0
    s_cmp_lt_u32 s63, 16
    s_nop 2
    s_cbranch_scc1 LW_84
    ds_read_b128 v[64:67], v23 offset:40960
    ds_read_b128 v[68:71], v23 offset:43136
    ds_read_b128 v[72:75], v23 offset:45312
    ds_read_b128 v[76:79], v23 offset:47488
    ds_read_b128 v[112:115], v28 offset:0
    ds_read_b128 v[116:119], v28 offset:2176
    ds_read_b128 v[120:123], v28 offset:4352
    ds_read_b128 v[124:127], v28 offset:6528
    s_waitcnt lgkmcnt(4)
    v_pk_add_f32 v[64:65], v[64:65], v[68:69]
    v_pk_add_f32 v[72:73], v[72:73], v[76:77]
    v_pk_add_f32 v[66:67], v[66:67], v[70:71]
    v_pk_add_f32 v[74:75], v[74:75], v[78:79]
    v_pk_add_f32 v[64:65], v[64:65], v[72:73]
    v_pk_add_f32 v[66:67], v[66:67], v[74:75]
    s_nop 1
    v_permlane32_swap_b32 v64, v66
    v_permlane32_swap_b32 v65, v67
    v_pk_add_f32 v[64:65], v[64:65], v[66:67]
    s_nop 1
    v_permlane16_swap_b32 v64, v65
    v_add_f32 v64, v64, v65
    s_waitcnt lgkmcnt(0)
    v_pk_add_f32 v[112:113], v[112:113], v[116:117]
    v_pk_add_f32 v[120:121], v[120:121], v[124:125]
    v_pk_add_f32 v[114:115], v[114:115], v[118:119]
    v_pk_add_f32 v[122:123], v[122:123], v[126:127]
    v_pk_add_f32 v[112:113], v[112:113], v[120:121]
    v_pk_add_f32 v[114:115], v[114:115], v[122:123]
    s_nop 1
    v_permlane32_swap_b32 v112, v114
    v_permlane32_swap_b32 v113, v115
    v_pk_add_f32 v[112:113], v[112:113], v[114:115]
    s_nop 1
    v_permlane16_swap_b32 v112, v113
    v_add_f32 v112, v112, v113
    v_mov_b32 v30, v64
    v_mov_b32 v31, v112
    s_nop 1
L_GUh:
    s_mov_b32 s65, 0
    s_branch LC_83
LP_82:
    buffer_load_dwordx4 v[80:83], v26, s[32:35], s59 offen sc1
    buffer_load_dwordx4 v[84:87], v26, s[32:35], s59 offen offset:512 sc1
LC_83:
    s_add_u32 s65, s65, 1
    s_waitcnt vmcnt(1)
    v_xor_b32 v80, v3, v80
    v_xor_b32 v81, v3, v81
    v_xor_b32 v82, v3, v82
    v_xor_b32 v83, v3, v83
    v_or3_b32 v4, v80, v81, v82
    v_or_b32 v4, v4, v83
    s_waitcnt vmcnt(0)
    v_xor_b32 v84, v3, v84
    v_xor_b32 v85, v3, v85
    v_xor_b32 v86, v3, v86
    v_xor_b32 v87, v3, v87
    v_or3_b32 v4, v4, v84, v85
    v_or3_b32 v4, v4, v86, v87
    v_and_b32 v4, 0xffff, v4
    v_cmp_ne_u32 vcc, 0, v4
    s_nop 4
    s_cbranch_vccz LD_81
    s_mov_b64 exec, vcc
    s_cmp_lt_u32 s65, 200000
    s_cbranch_scc1 LP_82
    s_branch L_end
LD_81:
    s_mov_b64 exec, -1
    v_pk_mul_f32 v[8:9], v[80:81], v[96:97]
    v_pk_mul_f32 v[10:11], v[82:83], v[98:99]
    v_pk_mul_f32 v[12:13], v[84:85], v[100:101]
    v_pk_mul_f32 v[14:15], v[86:87], v[102:103]
    v_cvt_pk_bf16_f32 v16, v8, v9
    v_cvt_pk_bf16_f32 v17, v10, v11
    v_cvt_pk_bf16_f32 v18, v12, v13
    v_cvt_pk_bf16_f32 v19, v14, v15
    v_perm_b32 v12, v81, v80, s54
    v_perm_b32 v13, v83, v82, s54
    v_perm_b32 v14, v85, v84, s54
    v_perm_b32 v15, v87, v86, s54
    v_permlane32_swap_b32 v16, v18
    v_permlane32_swap_b32 v17, v19
    v_mfma_f32_16x16x32_bf16 v[64:67], v[12:15], v[12:15], 0
    v_mfma_f32_16x16x32_bf16 v[68:71], v[12:15], v[88:91], 0
    v_mov_b32_dpp v8, v16 row_ror:8 row_mask:0xf bank_mask:0xf
    v_mov_b32_dpp v9, v17 row_ror:8 row_mask:0xf bank_mask:0xf
    v_mov_b32_dpp v10, v18 row_ror:8 row_mask:0xf bank_mask:0xf
    v_mov_b32_dpp v11, v19 row_ror:8 row_mask:0xf bank_mask:0xf
    v_mfma_f32_16x16x32_bf16 v[112:115], v[16:19], v[32:35], 0
    v_mfma_f32_16x16x32_bf16 v[116:119], v[16:19], v[36:39], 0
    v_mfma_f32_16x16x32_bf16 v[120:123], v[16:19], v[40:43], 0
    v_mfma_f32_16x16x32_bf16 v[124:127], v[16:19], v[44:47], 0
    v_mfma_f32_16x16x32_bf16 v[112:115], v[8:11], v[48:51], v[112:115]
    v_mfma_f32_16x16x32_bf16 v[120:123], v[8:11], v[56:59], v[120:123]
    v_mfma_f32_16x16x32_bf16 v[116:119], v[8:11], v[52:55], v[116:119]
    v_mfma_f32_16x16x32_bf16 v[124:127], v[8:11], v[60:63], v[124:127]
    v_cndmask_b32 v68, v68, v69, s[6:7]
    v_cndmask_b32 v64, v64, v65, s[6:7]
    v_cndmask_b32 v68, v68, v70, s[8:9]
    v_cndmask_b32 v64, v64, v66, s[8:9]
    v_cndmask_b32 v68, v68, v71, s[10:11]
    v_cndmask_b32 v64, v64, v67, s[10:11]
    s_mov_b32 exec_lo, 0x00f0000f
    s_mov_b32 exec_hi, 0xf0000f00
    ds_write2_b32 v25, v68, v64 offset0:0 offset1:32
    s_mov_b64 exec, -1
    v_permlane32_swap_b32 v112, v120
    v_permlane32_swap_b32 v113, v121
    v_permlane32_swap_b32 v114, v122
    v_permlane32_swap_b32 v115, v123
    ds_write_b128 v22, v[112:115] offset:6144
    v_permlane32_swap_b32 v116, v124
    v_permlane32_swap_b32 v117, v125
    v_permlane32_swap_b32 v118, v126
    v_permlane32_swap_b32 v119, v127
    ds_write_b128 v22, v[116:119] offset:6160
    s_cmp_lg_u32 s50, 15
    s_cbranch_scc1 LNF_85
    s_mov_b64 exec, 1
    buffer_store_dword v3, v21, s[32:35], s61 offen sc1
    s_mov_b64 exec, -1
LNF_85:
    s_waitcnt lgkmcnt(0)
    s_barrier
    s_cmp_ge_u32 s50, 8
    s_cbranch_scc1 L_fin
    ds_read_b128 v[8:11], v29 offset:2048
    ds_read_b128 v[12:15], v29 offset:2064
    ds_read_b128 v[32:35], v23 offset:6144
    ds_read_b128 v[36:39], v23 offset:8320
    ds_read_b128 v[40:43], v23 offset:10496
    ds_read_b128 v[44:47], v23 offset:12672
    v_mov_b32 v20, 0x3a800000
    s_waitcnt lgkmcnt(4)
    v_pk_add_f32 v[8:9], v[8:9], v[10:11]
    v_pk_add_f32 v[12:13], v[12:13], v[14:15]
    v_pk_add_f32 v[8:9], v[8:9], v[12:13]
    v_add_f32 v8, v8, v9
    s_nop 1
    v_add_f32_dpp v8, v8, v8 quad_perm:[1,0,3,2] row_mask:0xf bank_mask:0xf
    s_nop 1
    v_add_f32_dpp v8, v8, v8 quad_perm:[2,3,0,1] row_mask:0xf bank_mask:0xf
    s_waitcnt lgkmcnt(0)
    v_mul_f32 v9, 0x3a800000, v8
    v_pk_add_f32 v[32:33], v[32:33], v[36:37]
    v_mul_f32 v10, 0x3a800000, v8
    v_pk_add_f32 v[34:35], v[34:35], v[38:39]
    s_nop 0
    v_mov_b32_dpp v9, v10 row_half_mirror row_mask:0xf bank_mask:0xa
    v_pk_add_f32 v[40:41], v[40:41], v[44:45]
    v_mul_f32_dpp v10, v8, v20 row_half_mirror row_mask:0xf bank_mask:0x5
    v_pk_add_f32 v[42:43], v[42:43], v[46:47]
    v_fma_f32 v10, -v9, v9, v10
    v_pk_add_f32 v[32:33], v[32:33], v[40:41]
    v_max_f32 v10, 0, v10
    v_pk_add_f32 v[34:35], v[34:35], v[42:43]
    v_cvt_pk_bf16_f32 v7, v9, v10
    s_nop 0
    v_permlane32_swap_b32 v32, v34
    v_and_b32 v10, 0xffff0000, v7
    v_permlane32_swap_b32 v33, v35
    v_lshlrev_b32 v9, 16, v7
    v_pk_add_f32 v[32:33], v[32:33], v[34:35]
    v_add_f32 v10, 0x3727c5ac, v10
    s_nop 0
    v_permlane16_swap_b32 v32, v33
    v_cvt_pk_bf16_f32 v10, v10, v10
    v_add_f32 v32, v32, v33
    v_and_b32 v10, 0xffff0000, v10
    v_fma_f32 v32, -v9, v30, v32
    v_sqrt_f32 v10, v10
    s_nop 0
    v_cvt_pk_bf16_f32 v10, v10, v10
    v_and_b32 v10, 0xffff0000, v10
    v_rcp_f32 v10, v10
    s_nop 0
    v_fma_f32 v32, v32, v10, v31
    s_cmp_eq_u32 s69, 1
    s_nop 0
    s_cbranch_scc1 L_GUu
    v_cvt_pk_bf16_f32 v32, v32, v32
    v_and_b32 v32, 0xffff0000, v32
    v_mul_f32 v34, 0xbfb8aa3b, v32
    v_exp_f32 v34, v34
    s_nop 0
    v_add_f32 v34, 1.0, v34
    v_rcp_f32 v34, v34
    s_nop 0
    v_mul_f32 v32, v32, v34
    s_nop 1
L_GUu:
    v_cvt_pk_bf16_f32 v32, v32, v32
    v_and_or_b32 v32, v32, s55, v3
    s_nop 1
    v_mov_b32_dpp v36, v32 quad_perm:[0,0,0,0] row_mask:0xf bank_mask:0xf
    v_mov_b32_dpp v37, v32 quad_perm:[1,1,1,1] row_mask:0xf bank_mask:0xf
    v_mov_b32_dpp v38, v32 quad_perm:[2,2,2,2] row_mask:0xf bank_mask:0xf
    v_mov_b32_dpp v39, v32 quad_perm:[3,3,3,3] row_mask:0xf bank_mask:0xf
    s_mov_b32 exec_lo, 0x11111111
    s_mov_b32 exec_hi, 0x11111111
    buffer_store_dwordx4 v[36:39], v24, s[32:35], s60 offen sc1
    s_mov_b64 exec, -1
    s_nop 0
    s_branch L_fin
L_fin:
L_end:
    s_endpgm
.section .rodata,"a"
.p2align 6
.amdhsa_kernel adaLN_cond__sliding_block_cached__swiglu_ffn__decode_kernel
  .amdhsa_next_free_vgpr 128
  .amdhsa_next_free_sgpr 102
  .amdhsa_accum_offset 128
  .amdhsa_group_segment_fixed_size 0
  .amdhsa_kernarg_size 112
  .amdhsa_user_sgpr_count 2
  .amdhsa_user_sgpr_kernarg_segment_ptr 1
  .amdhsa_system_sgpr_workgroup_id_x 1
  .amdhsa_float_denorm_mode_32 3
  .amdhsa_float_denorm_mode_16_64 3
.end_amdhsa_kernel
```
